```python
import torch

def _softmax(x, axis=-1):
    return torch.softmax(x, dim=axis)
def _gelu(x):
    return torch.nn.functional.gelu(x, approximate="tanh")
def _silu(x):
    return torch.nn.functional.silu(x)
def _sigmoid(x):
    return torch.sigmoid(x)
def _layernorm(x, axis=-1, eps=1e-5):
    m = x.mean(dim=axis, keepdim=True)
    v = x.var(dim=axis, keepdim=True, unbiased=False)
    return (x - m) / torch.sqrt(v + eps)
def _scatter_add(tgt, idx, src, axis=0):
    return tgt.clone().index_add_(axis, idx, src)
def _segment_sum(src, seg, n):
    out = torch.zeros((n,) + src.shape[1:], dtype=src.dtype)
    return out.index_add_(0, seg, src)
def _pad(x, pw):
    flat = tuple(v for pair in reversed(pw) for v in pair)
    return torch.nn.functional.pad(x, flat)

kernel_name = 'standalone__w4a16_gemm_dequant__prompt'

def setup_inputs():

    _w = (lambda a: (lambda t: t.to(torch.bfloat16) if t.is_floating_point() else t)(torch.as_tensor(a)))
    B, S, D, F = 1, 2048, 1024, 3584
    G = 32 if 32 > 0 else D
    D = (D // G) * G
    ng = D // G
    qw = torch.randint(0, 16, (D, F)).to(torch.int32)
    return {
        "x": _w((lambda *s: torch.randn(*s, dtype=torch.bfloat16) * 0.05)(B, S, D)),
        "qw": _w(qw),
        "scales": _w(torch.abs((lambda *s: torch.randn(*s, dtype=torch.bfloat16) * 0.05)(ng, F)) + 0.01),
        "zeros": _w(torch.full((ng, F), 8.0, dtype=float)),
    }

def reference(x, qw, scales, zeros):
    B, S, D = x.shape
    ng, F = scales.shape
    G = D // ng
    s = (lambda x, n, axis: torch.repeat_interleave(x, n, dim=axis))(scales, G, axis=0)
    z = (lambda x, n, axis: torch.repeat_interleave(x, n, dim=axis))(zeros, G, axis=0)
    w = ((lambda x, dt: x.to(dt))(qw, x.dtype) - z) * s
    return x @ w
```

```asm
; @launch grid=(256,1,1) block=(512,1,1) lds=147456
.amdgcn_target "amdgcn-amd-amdhsa--gfx950"
.text
.globl standalone__w4a16_gemm_dequant__prompt_kernel
.p2align 8
.type standalone__w4a16_gemm_dequant__prompt_kernel,@function
standalone__w4a16_gemm_dequant__prompt_kernel:
    s_load_dwordx8 s[4:11], s[0:1], 0
    s_load_dwordx2 s[12:13], s[0:1], 32
    s_load_dwordx2 s[16:17], s[0:1], 48
    v_lshrrev_b32 v1, 6, v0
    s_cmp_ge_u32 s2, 256
    s_cbranch_scc1 L_end
    v_readfirstlane_b32 s22, v1
    s_cmp_lt_u32 s22, 6
    s_cbranch_scc1 L_nopf
    s_getpc_b64 s[18:19]
    s_and_b32 s24, s2, 0xf8
    s_lshl_b32 s25, s22, 2
    s_add_u32 s24, s24, s25
    s_lshl_b32 s24, s24, 5
    s_and_b32 s18, s18, 0xffffff00
    s_or_b32 s24, s24, 60
    s_load_dwordx2 s[14:15], s[18:19], s24
    s_add_u32 s24, s24, 8192
    s_min_u32 s24, s24, ((L_codeend-standalone__w4a16_gemm_dequant__prompt_kernel)&0xffff80)+60
    s_load_dwordx2 s[14:15], s[18:19], s24
L_nopf:
    v_bfe_u32 v6, v0, 5, 1
    v_and_b32 v7, 31, v0
    v_mul_u32_u24 v4, 114688, v6
    v_lshl_add_u32 v4, v7, 4, v4
    v_lshlrev_b32 v5, 3, v7
    v_and_b32 v2, 63, v0
    s_cmp_lt_u32 s2, 32
    s_cbranch_scc1 L_prod
    s_bfe_u32 s20, s2, 0x20003
    s_and_b32 s25, s2, 1
    s_lshl_b32 s25, s25, 2
    s_add_u32 s20, s20, s25
    s_lshr_b32 s21, s2, 5
    s_bfe_u32 s25, s2, 0x20001
    s_mul_i32 s25, s25, 7
    s_add_u32 s21, s21, s25
    s_sub_u32 s21, s21, 1
    s_cmp_ge_u32 s22, 4
    s_cbranch_scc1 L_help
    s_and_b32 s56, s20, 7
    s_lshl_b32 s56, s56, 2
    s_add_u32 s56, s56, s22
    s_mul_i32 s53, s56, 229376
    s_lshl_b32 s25, s21, 9
    s_add_u32 s53, s53, s25
    s_lshr_b32 s54, s56, 1
    s_mul_i32 s54, s54, 7168
    s_lshl_b32 s25, s21, 8
    s_add_u32 s54, s54, s25
    s_lshl_b32 s30, s21, 7
    s_add_u32 s30, s30, 7598080
    s_mov_b32 s38, 14680064
    s_mov_b32 s39, 0x20000
    s_mov_b32 s42, 229376
    s_mov_b32 s43, 0x20000
    s_mov_b32 s46, 229376
    s_mov_b32 s47, 0x20000
    s_waitcnt lgkmcnt(0)
    s_mov_b32 s36, s6
    s_and_b32 s37, s7, 0xffff
    s_mov_b32 s40, s8
    s_and_b32 s41, s9, 0xffff
    s_mov_b32 s44, s10
    s_and_b32 s45, s11, 0xffff
    buffer_load_dwordx4 v[32:35], v4, s[36:39], s53 offen
    s_add_u32 s34, s53, 14336
    buffer_load_dwordx4 v[36:39], v4, s[36:39], s34 offen
    s_add_u32 s34, s53, 28672
    buffer_load_dwordx4 v[40:43], v4, s[36:39], s34 offen
    s_add_u32 s34, s53, 43008
    buffer_load_dwordx4 v[44:47], v4, s[36:39], s34 offen
    s_add_u32 s34, s53, 57344
    buffer_load_dwordx4 v[48:51], v4, s[36:39], s34 offen
    s_add_u32 s34, s53, 71680
    buffer_load_dwordx4 v[52:55], v4, s[36:39], s34 offen
    s_add_u32 s34, s53, 86016
    buffer_load_dwordx4 v[56:59], v4, s[36:39], s34 offen
    s_add_u32 s34, s53, 100352
    buffer_load_dwordx4 v[60:63], v4, s[36:39], s34 offen
    buffer_load_dwordx2 v[64:65], v5, s[40:43], s54 offen
    buffer_load_dwordx2 v[66:67], v5, s[44:47], s54 offen
    s_load_dword s23, s[16:17], s30
    s_mov_b32 s48, s16
    s_and_b32 s49, s17, 0xffff
    s_mov_b32 s50, 8388608
    s_mov_b32 s51, 0x20000
    v_xor_b32 v8, v7, v6
    v_lshlrev_b32 v8, 4, v8
    v_lshl_add_u32 v8, v6, 11, v8
    v_cmp_gt_u32 vcc, 32, v2
    v_lshlrev_b32 v3, 2, v2
    v_mov_b32 v9, 1073741824
    v_cndmask_b32 v25, v9, v3, vcc
    s_mul_i32 s35, s21, 262144
    s_lshl_b32 s25, s56, 12
    s_add_u32 s35, s35, s25
    s_mul_i32 s58, s21, 9216
    s_add_u32 s58, s58, 7340032
    s_lshl_b32 s25, s56, 7
    s_add_u32 s52, s58, s25
    s_lshl_b32 s24, s22, 12
    s_add_u32 s24, s24, 32768
    v_add_u32 v9, s24, v8
    v_and_b32 v10, 15, v2
    v_lshrrev_b32 v11, 4, v2
    v_and_b32 v12, 6, v2
    v_xor_b32 v12, v12, v11
    s_lshl_b32 s24, s22, 13
    v_lshl_add_u32 v13, v10, 7, s24
    v_lshl_add_u32 v16, v12, 4, v13
    v_xor_b32 v17, 64, v16
    v_and_b32 v12, 1, v11
    v_lshl_add_u32 v12, v10, 1, v12
    v_lshlrev_b32 v12, 4, v12
    v_lshl_add_u32 v18, v11, 11, v12
    v_add_u32 v18, 32768, v18
    v_xor_b32 v19, 16, v18
    v_mov_b32 v20, v16
    v_mov_b32 v21, v17
    v_mov_b32 v22, v18
    v_mov_b32 v23, v19
    v_mul_u32_u24 v24, 28672, v11
    v_lshl_add_u32 v24, v10, 4, v24
    s_lshl_b32 s29, s20, 2
    s_add_u32 s29, s29, s22
    s_mul_i32 s29, s29, 458752
    s_lshl_b32 s24, s21, 8
    s_add_u32 s29, s29, s24
    s_xor_b32 s56, s56, 4
    s_mul_i32 s53, s56, 229376
    s_lshl_b32 s25, s21, 9
    s_add_u32 s53, s53, s25
    s_lshr_b32 s54, s56, 1
    s_mul_i32 s54, s54, 7168
    s_lshl_b32 s25, s21, 8
    s_add_u32 s54, s54, s25
    s_mov_b32 s32, 0
    s_mov_b32 s33, 12
    s_waitcnt vmcnt(0)
    v_lshlrev_b32 v68, 16, v64
    v_lshlrev_b32 v72, 16, v66
    v_and_b32 v69, 0xffff0000, v64
    v_and_b32 v73, 0xffff0000, v66
    v_lshlrev_b32 v70, 16, v65
    v_lshlrev_b32 v74, 16, v67
    v_and_b32 v71, 0xffff0000, v65
    v_and_b32 v75, 0xffff0000, v67
    v_mul_f32_e64 v72, -v72, v68
    v_mul_f32_e64 v73, -v73, v69
    v_mul_f32_e64 v74, -v74, v70
    v_mul_f32_e64 v75, -v75, v71
    v_cvt_f32_i32 v32, v32
    v_cvt_f32_i32 v36, v36
    v_cvt_f32_i32 v40, v40
    v_cvt_f32_i32 v44, v44
    v_cvt_f32_i32 v48, v48
    v_cvt_f32_i32 v52, v52
    v_cvt_f32_i32 v56, v56
    v_cvt_f32_i32 v60, v60
    v_fma_f32 v32, v32, v68, v72
    v_fma_f32 v36, v36, v68, v72
    v_fma_f32 v40, v40, v68, v72
    v_fma_f32 v44, v44, v68, v72
    v_fma_f32 v48, v48, v68, v72
    v_fma_f32 v52, v52, v68, v72
    v_fma_f32 v56, v56, v68, v72
    v_fma_f32 v60, v60, v68, v72
    v_cvt_pk_bf16_f32 v128, v32, v36
    v_cvt_pk_bf16_f32 v129, v40, v44
    v_cvt_pk_bf16_f32 v130, v48, v52
    v_cvt_pk_bf16_f32 v131, v56, v60
    buffer_store_dwordx4 v[128:131], v8, s[48:51], s35 offen offset:0 sc1
    v_cvt_f32_i32 v33, v33
    v_cvt_f32_i32 v37, v37
    v_cvt_f32_i32 v41, v41
    v_cvt_f32_i32 v45, v45
    v_cvt_f32_i32 v49, v49
    v_cvt_f32_i32 v53, v53
    v_cvt_f32_i32 v57, v57
    v_cvt_f32_i32 v61, v61
    v_fma_f32 v33, v33, v69, v73
    v_fma_f32 v37, v37, v69, v73
    v_fma_f32 v41, v41, v69, v73
    v_fma_f32 v45, v45, v69, v73
    v_fma_f32 v49, v49, v69, v73
    v_fma_f32 v53, v53, v69, v73
    v_fma_f32 v57, v57, v69, v73
    v_fma_f32 v61, v61, v69, v73
    v_cvt_pk_bf16_f32 v132, v33, v37
    v_cvt_pk_bf16_f32 v133, v41, v45
    v_cvt_pk_bf16_f32 v134, v49, v53
    v_cvt_pk_bf16_f32 v135, v57, v61
    buffer_store_dwordx4 v[132:135], v8, s[48:51], s35 offen offset:512 sc1
    v_cvt_f32_i32 v34, v34
    v_cvt_f32_i32 v38, v38
    v_cvt_f32_i32 v42, v42
    v_cvt_f32_i32 v46, v46
    v_cvt_f32_i32 v50, v50
    v_cvt_f32_i32 v54, v54
    v_cvt_f32_i32 v58, v58
    v_cvt_f32_i32 v62, v62
    v_fma_f32 v34, v34, v70, v74
    v_fma_f32 v38, v38, v70, v74
    v_fma_f32 v42, v42, v70, v74
    v_fma_f32 v46, v46, v70, v74
    v_fma_f32 v50, v50, v70, v74
    v_fma_f32 v54, v54, v70, v74
    v_fma_f32 v58, v58, v70, v74
    v_fma_f32 v62, v62, v70, v74
    v_cvt_pk_bf16_f32 v136, v34, v38
    v_cvt_pk_bf16_f32 v137, v42, v46
    v_cvt_pk_bf16_f32 v138, v50, v54
    v_cvt_pk_bf16_f32 v139, v58, v62
    buffer_store_dwordx4 v[136:139], v8, s[48:51], s35 offen offset:1024 sc1
    v_cvt_f32_i32 v35, v35
    v_cvt_f32_i32 v39, v39
    v_cvt_f32_i32 v43, v43
    v_cvt_f32_i32 v47, v47
    v_cvt_f32_i32 v51, v51
    v_cvt_f32_i32 v55, v55
    v_cvt_f32_i32 v59, v59
    v_cvt_f32_i32 v63, v63
    v_fma_f32 v35, v35, v71, v75
    v_fma_f32 v39, v39, v71, v75
    v_fma_f32 v43, v43, v71, v75
    v_fma_f32 v47, v47, v71, v75
    v_fma_f32 v51, v51, v71, v75
    v_fma_f32 v55, v55, v71, v75
    v_fma_f32 v59, v59, v71, v75
    v_fma_f32 v63, v63, v71, v75
    v_cvt_pk_bf16_f32 v140, v35, v39
    v_cvt_pk_bf16_f32 v141, v43, v47
    v_cvt_pk_bf16_f32 v142, v51, v55
    v_cvt_pk_bf16_f32 v143, v59, v63
    buffer_store_dwordx4 v[140:143], v8, s[48:51], s35 offen offset:1536 sc1
    s_waitcnt lgkmcnt(0)
    s_add_u32 s59, s23, 2654435761
    s_or_b32 s59, s59, 1
    v_mov_b32 v26, s59
    buffer_load_dwordx4 v[80:83], v4, s[36:39], s53 offen
    s_add_u32 s34, s53, 14336
    buffer_load_dwordx4 v[84:87], v4, s[36:39], s34 offen
    s_add_u32 s34, s53, 28672
    buffer_load_dwordx4 v[88:91], v4, s[36:39], s34 offen
    s_add_u32 s34, s53, 43008
    buffer_load_dwordx4 v[92:95], v4, s[36:39], s34 offen
    s_add_u32 s34, s53, 57344
    buffer_load_dwordx4 v[96:99], v4, s[36:39], s34 offen
    s_add_u32 s34, s53, 71680
    buffer_load_dwordx4 v[100:103], v4, s[36:39], s34 offen
    s_add_u32 s34, s53, 86016
    buffer_load_dwordx4 v[104:107], v4, s[36:39], s34 offen
    s_add_u32 s34, s53, 100352
    buffer_load_dwordx4 v[108:111], v4, s[36:39], s34 offen
    buffer_load_dwordx2 v[112:113], v5, s[40:43], s54 offen
    buffer_load_dwordx2 v[114:115], v5, s[44:47], s54 offen
    s_mov_b32 s36, s12
    s_and_b32 s37, s13, 0xffff
    s_mov_b32 s38, 14680064
    s_mov_b32 s39, 0x20000
    ds_write_b128 v9, v[128:131] offset:0
    ds_write_b128 v9, v[132:135] offset:512
    ds_write_b128 v9, v[136:139] offset:1024
    ds_write_b128 v9, v[140:143] offset:1536
    s_setprio 1
    s_waitcnt lgkmcnt(0)
    s_barrier
    ds_read_b128 v[48:51], v22 offset:0
    ds_read_b128 v[32:35], v20 offset:0
    ds_read_b128 v[36:39], v20 offset:2048
    ds_read_b128 v[40:43], v20 offset:4096
    ds_read_b128 v[44:47], v20 offset:6144
    ds_read_b128 v[52:55], v22 offset:512
    ds_read_b128 v[56:59], v22 offset:1024
    ds_read_b128 v[60:63], v22 offset:1536
    ds_read_b128 v[64:67], v23 offset:0
    ds_read_b128 v[68:71], v23 offset:512
    ds_read_b128 v[72:75], v23 offset:1024
    ds_read_b128 v[76:79], v23 offset:1536
    s_waitcnt lgkmcnt(0)
    v_mfma_f32_16x16x32_bf16 v[128:131], v[32:35], v[48:51], 0
    v_mfma_f32_16x16x32_bf16 v[160:163], v[36:39], v[48:51], 0
    v_mfma_f32_16x16x32_bf16 v[192:195], v[40:43], v[48:51], 0
    v_mfma_f32_16x16x32_bf16 v[224:227], v[44:47], v[48:51], 0
    v_mfma_f32_16x16x32_bf16 v[132:135], v[32:35], v[52:55], 0
    v_mfma_f32_16x16x32_bf16 v[164:167], v[36:39], v[52:55], 0
    ds_read_b128 v[48:51], v22 offset:8192
    v_mfma_f32_16x16x32_bf16 v[196:199], v[40:43], v[52:55], 0
    v_mfma_f32_16x16x32_bf16 v[228:231], v[44:47], v[52:55], 0
    v_mfma_f32_16x16x32_bf16 v[136:139], v[32:35], v[56:59], 0
    v_mfma_f32_16x16x32_bf16 v[168:171], v[36:39], v[56:59], 0
    ds_read_b128 v[52:55], v22 offset:8704
    v_mfma_f32_16x16x32_bf16 v[200:203], v[40:43], v[56:59], 0
    v_mfma_f32_16x16x32_bf16 v[232:235], v[44:47], v[56:59], 0
    v_mfma_f32_16x16x32_bf16 v[140:143], v[32:35], v[60:63], 0
    s_waitcnt vmcnt(10)
    buffer_store_dword v26, v25, s[48:51], s52 offen sc1
    v_mfma_f32_16x16x32_bf16 v[172:175], v[36:39], v[60:63], 0
    ds_read_b128 v[56:59], v22 offset:9216
    s_waitcnt vmcnt(1)
    v_mfma_f32_16x16x32_bf16 v[204:207], v[40:43], v[60:63], 0
    v_lshlrev_b32 v116, 16, v112
    v_lshlrev_b32 v120, 16, v114
    v_mfma_f32_16x16x32_bf16 v[236:239], v[44:47], v[60:63], 0
    v_and_b32 v117, 0xffff0000, v112
    v_and_b32 v121, 0xffff0000, v114
    v_mfma_f32_16x16x32_bf16 v[144:147], v[32:35], v[64:67], 0
    v_lshlrev_b32 v118, 16, v113
    v_lshlrev_b32 v122, 16, v115
    v_mfma_f32_16x16x32_bf16 v[176:179], v[36:39], v[64:67], 0
    ds_read_b128 v[60:63], v22 offset:9728
    v_and_b32 v119, 0xffff0000, v113
    v_mfma_f32_16x16x32_bf16 v[208:211], v[40:43], v[64:67], 0
    v_and_b32 v123, 0xffff0000, v115
    v_mul_f32_e64 v120, -v120, v116
    v_mfma_f32_16x16x32_bf16 v[240:243], v[44:47], v[64:67], 0
    v_mul_f32_e64 v121, -v121, v117
    v_mul_f32_e64 v122, -v122, v118
    v_mfma_f32_16x16x32_bf16 v[148:151], v[32:35], v[68:71], 0
    v_mul_f32_e64 v123, -v123, v119
    v_cvt_f32_i32 v80, v80
    v_mfma_f32_16x16x32_bf16 v[180:183], v[36:39], v[68:71], 0
    ds_read_b128 v[64:67], v23 offset:8192
    v_cvt_f32_i32 v84, v84
    v_mfma_f32_16x16x32_bf16 v[212:215], v[40:43], v[68:71], 0
    v_cvt_f32_i32 v88, v88
    v_cvt_f32_i32 v92, v92
    v_mfma_f32_16x16x32_bf16 v[244:247], v[44:47], v[68:71], 0
    v_cvt_f32_i32 v96, v96
    v_cvt_f32_i32 v100, v100
    v_mfma_f32_16x16x32_bf16 v[152:155], v[32:35], v[72:75], 0
    v_cvt_f32_i32 v104, v104
    v_cvt_f32_i32 v108, v108
    v_mfma_f32_16x16x32_bf16 v[184:187], v[36:39], v[72:75], 0
    ds_read_b128 v[68:71], v23 offset:8704
    v_fma_f32 v80, v80, v116, v120
    v_mfma_f32_16x16x32_bf16 v[216:219], v[40:43], v[72:75], 0
    v_fma_f32 v84, v84, v116, v120
    v_fma_f32 v88, v88, v116, v120
    v_mfma_f32_16x16x32_bf16 v[248:251], v[44:47], v[72:75], 0
    v_fma_f32 v92, v92, v116, v120
    v_fma_f32 v96, v96, v116, v120
    v_mfma_f32_16x16x32_bf16 v[156:159], v[32:35], v[76:79], 0
    v_fma_f32 v100, v100, v116, v120
    v_fma_f32 v104, v104, v116, v120
    v_mfma_f32_16x16x32_bf16 v[188:191], v[36:39], v[76:79], 0
    ds_read_b128 v[72:75], v23 offset:9216
    v_fma_f32 v108, v108, v116, v120
    v_mfma_f32_16x16x32_bf16 v[220:223], v[40:43], v[76:79], 0
    v_cvt_pk_bf16_f32 v124, v80, v84
    v_cvt_pk_bf16_f32 v125, v88, v92
    v_mfma_f32_16x16x32_bf16 v[252:255], v[44:47], v[76:79], 0
    v_cvt_pk_bf16_f32 v126, v96, v100
    v_cvt_pk_bf16_f32 v127, v104, v108
    v_cvt_f32_i32 v81, v81
    v_cvt_f32_i32 v85, v85
    ds_read_b128 v[32:35], v21 offset:0
    ds_read_b128 v[36:39], v21 offset:2048
    ds_read_b128 v[40:43], v21 offset:4096
    ds_read_b128 v[44:47], v21 offset:6144
    ds_read_b128 v[76:79], v23 offset:9728
    s_mov_b32 s32, 49152
    v_add_u32 v20, s32, v16
    v_add_u32 v21, s32, v17
    v_add_u32 v22, s32, v18
    v_add_u32 v23, s32, v19
    v_cvt_f32_i32 v89, v89
    v_cvt_f32_i32 v93, v93
    v_cvt_f32_i32 v97, v97
    v_cvt_f32_i32 v101, v101
    v_cvt_f32_i32 v105, v105
    v_cvt_f32_i32 v109, v109
    v_fma_f32 v81, v81, v117, v121
    v_fma_f32 v85, v85, v117, v121
    v_fma_f32 v89, v89, v117, v121
    v_fma_f32 v93, v93, v117, v121
    v_fma_f32 v97, v97, v117, v121
    v_fma_f32 v101, v101, v117, v121
    v_fma_f32 v105, v105, v117, v121
    v_fma_f32 v109, v109, v117, v121
    v_cvt_pk_bf16_f32 v28, v81, v85
    v_cvt_pk_bf16_f32 v29, v89, v93
    v_cvt_pk_bf16_f32 v30, v97, v101
    v_cvt_pk_bf16_f32 v31, v105, v109
    s_waitcnt lgkmcnt(0)
    v_mfma_f32_16x16x32_bf16 v[128:131], v[32:35], v[48:51], v[128:131]
    v_cvt_f32_i32 v82, v82
    v_cvt_f32_i32 v86, v86
    v_mfma_f32_16x16x32_bf16 v[160:163], v[36:39], v[48:51], v[160:163]
    v_cvt_f32_i32 v90, v90
    v_cvt_f32_i32 v94, v94
    v_mfma_f32_16x16x32_bf16 v[192:195], v[40:43], v[48:51], v[192:195]
    v_cvt_f32_i32 v98, v98
    v_cvt_f32_i32 v102, v102
    v_mfma_f32_16x16x32_bf16 v[224:227], v[44:47], v[48:51], v[224:227]
    v_cvt_f32_i32 v106, v106
    v_cvt_f32_i32 v110, v110
    v_mfma_f32_16x16x32_bf16 v[132:135], v[32:35], v[52:55], v[132:135]
    v_fma_f32 v82, v82, v118, v122
    v_fma_f32 v86, v86, v118, v122
    v_mfma_f32_16x16x32_bf16 v[164:167], v[36:39], v[52:55], v[164:167]
    v_fma_f32 v90, v90, v118, v122
    v_fma_f32 v94, v94, v118, v122
    v_mfma_f32_16x16x32_bf16 v[196:199], v[40:43], v[52:55], v[196:199]
    v_fma_f32 v98, v98, v118, v122
    v_fma_f32 v102, v102, v118, v122
    v_mfma_f32_16x16x32_bf16 v[228:231], v[44:47], v[52:55], v[228:231]
    v_fma_f32 v106, v106, v118, v122
    v_fma_f32 v110, v110, v118, v122
    v_mfma_f32_16x16x32_bf16 v[136:139], v[32:35], v[56:59], v[136:139]
    v_cvt_pk_bf16_f32 v48, v82, v86
    v_cvt_pk_bf16_f32 v49, v90, v94
    v_mfma_f32_16x16x32_bf16 v[168:171], v[36:39], v[56:59], v[168:171]
    v_cvt_pk_bf16_f32 v50, v98, v102
    v_cvt_pk_bf16_f32 v51, v106, v110
    v_mfma_f32_16x16x32_bf16 v[200:203], v[40:43], v[56:59], v[200:203]
    v_cvt_f32_i32 v83, v83
    v_cvt_f32_i32 v87, v87
    v_mfma_f32_16x16x32_bf16 v[232:235], v[44:47], v[56:59], v[232:235]
    v_cvt_f32_i32 v91, v91
    v_cvt_f32_i32 v95, v95
    v_mfma_f32_16x16x32_bf16 v[140:143], v[32:35], v[60:63], v[140:143]
    v_cvt_f32_i32 v99, v99
    v_cvt_f32_i32 v103, v103
    v_mfma_f32_16x16x32_bf16 v[172:175], v[36:39], v[60:63], v[172:175]
    v_cvt_f32_i32 v107, v107
    v_cvt_f32_i32 v111, v111
    v_mfma_f32_16x16x32_bf16 v[204:207], v[40:43], v[60:63], v[204:207]
    v_fma_f32 v83, v83, v119, v123
    v_fma_f32 v87, v87, v119, v123
    v_mfma_f32_16x16x32_bf16 v[236:239], v[44:47], v[60:63], v[236:239]
    v_fma_f32 v91, v91, v119, v123
    v_fma_f32 v95, v95, v119, v123
    v_mfma_f32_16x16x32_bf16 v[144:147], v[32:35], v[64:67], v[144:147]
    v_fma_f32 v99, v99, v119, v123
    v_fma_f32 v103, v103, v119, v123
    v_mfma_f32_16x16x32_bf16 v[176:179], v[36:39], v[64:67], v[176:179]
    v_fma_f32 v107, v107, v119, v123
    v_fma_f32 v111, v111, v119, v123
    v_mfma_f32_16x16x32_bf16 v[208:211], v[40:43], v[64:67], v[208:211]
    v_cvt_pk_bf16_f32 v52, v83, v87
    v_cvt_pk_bf16_f32 v53, v91, v95
    v_mfma_f32_16x16x32_bf16 v[240:243], v[44:47], v[64:67], v[240:243]
    v_cvt_pk_bf16_f32 v54, v99, v103
    v_cvt_pk_bf16_f32 v55, v107, v111
    v_mfma_f32_16x16x32_bf16 v[148:151], v[32:35], v[68:71], v[148:151]
    v_mfma_f32_16x16x32_bf16 v[180:183], v[36:39], v[68:71], v[180:183]
    v_mfma_f32_16x16x32_bf16 v[212:215], v[40:43], v[68:71], v[212:215]
    v_mfma_f32_16x16x32_bf16 v[244:247], v[44:47], v[68:71], v[244:247]
    v_mfma_f32_16x16x32_bf16 v[152:155], v[32:35], v[72:75], v[152:155]
    v_mfma_f32_16x16x32_bf16 v[184:187], v[36:39], v[72:75], v[184:187]
    v_mfma_f32_16x16x32_bf16 v[216:219], v[40:43], v[72:75], v[216:219]
    ds_write_b128 v9, v[124:127] offset:49152
    ds_write_b128 v9, v[28:31] offset:49664
    v_mfma_f32_16x16x32_bf16 v[248:251], v[44:47], v[72:75], v[248:251]
    ds_write_b128 v9, v[48:51] offset:50176
    ds_write_b128 v9, v[52:55] offset:50688
    v_mfma_f32_16x16x32_bf16 v[156:159], v[32:35], v[76:79], v[156:159]
    v_mfma_f32_16x16x32_bf16 v[188:191], v[36:39], v[76:79], v[188:191]
    v_mfma_f32_16x16x32_bf16 v[220:223], v[40:43], v[76:79], v[220:223]
    v_mfma_f32_16x16x32_bf16 v[252:255], v[44:47], v[76:79], v[252:255]
    s_waitcnt lgkmcnt(0)
    s_branch L_pg
.p2align 12
L_pg:
    s_barrier
    ds_read_b128 v[96:99], v22 offset:0
    ds_read_b128 v[32:35], v20 offset:0
    ds_read_b128 v[100:103], v22 offset:8192
    ds_read_b128 v[36:39], v21 offset:0
    ds_read_b128 v[40:43], v20 offset:2048
    ds_read_b128 v[44:47], v21 offset:2048
    ds_read_b128 v[48:51], v20 offset:4096
    ds_read_b128 v[52:55], v21 offset:4096
    ds_read_b128 v[56:59], v20 offset:6144
    ds_read_b128 v[60:63], v21 offset:6144
    ds_read_b128 v[104:107], v22 offset:512
    ds_read_b128 v[108:111], v22 offset:8704
    ds_read_b128 v[112:115], v22 offset:1024
    ds_read_b128 v[116:119], v22 offset:9216
.p2align 6
L_cloop:
    s_waitcnt lgkmcnt(10)
    v_mfma_f32_16x16x32_bf16 v[128:131], v[32:35], v[96:99], v[128:131]
    ds_read_b128 v[120:123], v22 offset:1536
    v_mfma_f32_16x16x32_bf16 v[128:131], v[36:39], v[100:103], v[128:131]
    ds_read_b128 v[124:127], v22 offset:9728
    s_waitcnt lgkmcnt(10)
    v_mfma_f32_16x16x32_bf16 v[160:163], v[40:43], v[96:99], v[160:163]
    v_mfma_f32_16x16x32_bf16 v[160:163], v[44:47], v[100:103], v[160:163]
    s_add_u32 s32, s32, 49152
    s_waitcnt lgkmcnt(8)
    v_mfma_f32_16x16x32_bf16 v[192:195], v[48:51], v[96:99], v[192:195]
    v_mfma_f32_16x16x32_bf16 v[192:195], v[52:55], v[100:103], v[192:195]
    s_cmp_eq_u32 s32, 147456
    s_waitcnt lgkmcnt(6)
    v_mfma_f32_16x16x32_bf16 v[224:227], v[56:59], v[96:99], v[224:227]
    v_mfma_f32_16x16x32_bf16 v[224:227], v[60:63], v[100:103], v[224:227]
    s_cselect_b32 s32, 0, s32
    s_waitcnt lgkmcnt(4)
    v_mfma_f32_16x16x32_bf16 v[228:231], v[56:59], v[104:107], v[228:231]
    ds_read_b128 v[96:99], v23 offset:0
    v_mfma_f32_16x16x32_bf16 v[228:231], v[60:63], v[108:111], v[228:231]
    ds_read_b128 v[100:103], v23 offset:8192
    v_mfma_f32_16x16x32_bf16 v[196:199], v[48:51], v[104:107], v[196:199]
    v_mfma_f32_16x16x32_bf16 v[196:199], v[52:55], v[108:111], v[196:199]
    v_mfma_f32_16x16x32_bf16 v[164:167], v[40:43], v[104:107], v[164:167]
    v_mfma_f32_16x16x32_bf16 v[164:167], v[44:47], v[108:111], v[164:167]
    v_mfma_f32_16x16x32_bf16 v[132:135], v[32:35], v[104:107], v[132:135]
    v_mfma_f32_16x16x32_bf16 v[132:135], v[36:39], v[108:111], v[132:135]
    s_waitcnt lgkmcnt(4)
    v_mfma_f32_16x16x32_bf16 v[136:139], v[32:35], v[112:115], v[136:139]
    ds_read_b128 v[104:107], v23 offset:512
    v_mfma_f32_16x16x32_bf16 v[136:139], v[36:39], v[116:119], v[136:139]
    ds_read_b128 v[108:111], v23 offset:8704
    v_mfma_f32_16x16x32_bf16 v[168:171], v[40:43], v[112:115], v[168:171]
    v_mfma_f32_16x16x32_bf16 v[168:171], v[44:47], v[116:119], v[168:171]
    v_mfma_f32_16x16x32_bf16 v[200:203], v[48:51], v[112:115], v[200:203]
    v_mfma_f32_16x16x32_bf16 v[200:203], v[52:55], v[116:119], v[200:203]
    v_mfma_f32_16x16x32_bf16 v[232:235], v[56:59], v[112:115], v[232:235]
    v_mfma_f32_16x16x32_bf16 v[232:235], v[60:63], v[116:119], v[232:235]
    s_waitcnt lgkmcnt(4)
    v_mfma_f32_16x16x32_bf16 v[236:239], v[56:59], v[120:123], v[236:239]
    ds_read_b128 v[112:115], v23 offset:1024
    v_mfma_f32_16x16x32_bf16 v[236:239], v[60:63], v[124:127], v[236:239]
    ds_read_b128 v[116:119], v23 offset:9216
    v_mfma_f32_16x16x32_bf16 v[204:207], v[48:51], v[120:123], v[204:207]
    v_mfma_f32_16x16x32_bf16 v[204:207], v[52:55], v[124:127], v[204:207]
    v_mfma_f32_16x16x32_bf16 v[172:175], v[40:43], v[120:123], v[172:175]
    v_mfma_f32_16x16x32_bf16 v[172:175], v[44:47], v[124:127], v[172:175]
    v_mfma_f32_16x16x32_bf16 v[140:143], v[32:35], v[120:123], v[140:143]
    v_mfma_f32_16x16x32_bf16 v[140:143], v[36:39], v[124:127], v[140:143]
    s_waitcnt lgkmcnt(4)
    v_mfma_f32_16x16x32_bf16 v[144:147], v[32:35], v[96:99], v[144:147]
    ds_read_b128 v[120:123], v23 offset:1536
    v_mfma_f32_16x16x32_bf16 v[144:147], v[36:39], v[100:103], v[144:147]
    ds_read_b128 v[124:127], v23 offset:9728
    v_add_u32 v22, s32, v18
    v_mfma_f32_16x16x32_bf16 v[176:179], v[40:43], v[96:99], v[176:179]
    v_add_u32 v20, s32, v16
    v_add_u32 v21, s32, v17
    v_mfma_f32_16x16x32_bf16 v[176:179], v[44:47], v[100:103], v[176:179]
    v_add_u32 v23, s32, v19
    v_mfma_f32_16x16x32_bf16 v[208:211], v[48:51], v[96:99], v[208:211]
    v_mfma_f32_16x16x32_bf16 v[208:211], v[52:55], v[100:103], v[208:211]
    v_mfma_f32_16x16x32_bf16 v[240:243], v[56:59], v[96:99], v[240:243]
    v_mfma_f32_16x16x32_bf16 v[240:243], v[60:63], v[100:103], v[240:243]
    s_waitcnt lgkmcnt(4)
    v_mfma_f32_16x16x32_bf16 v[244:247], v[56:59], v[104:107], v[244:247]
    v_mfma_f32_16x16x32_bf16 v[244:247], v[60:63], v[108:111], v[244:247]
    s_waitcnt lgkmcnt(0)
    s_barrier
    v_mfma_f32_16x16x32_bf16 v[212:215], v[48:51], v[104:107], v[212:215]
    ds_read_b128 v[96:99], v22 offset:0
    v_mfma_f32_16x16x32_bf16 v[212:215], v[52:55], v[108:111], v[212:215]
    ds_read_b128 v[64:67], v20 offset:0
    v_mfma_f32_16x16x32_bf16 v[180:183], v[40:43], v[104:107], v[180:183]
    ds_read_b128 v[100:103], v22 offset:8192
    v_mfma_f32_16x16x32_bf16 v[180:183], v[44:47], v[108:111], v[180:183]
    ds_read_b128 v[68:71], v21 offset:0
    v_mfma_f32_16x16x32_bf16 v[148:151], v[32:35], v[104:107], v[148:151]
    ds_read_b128 v[72:75], v20 offset:2048
    v_mfma_f32_16x16x32_bf16 v[148:151], v[36:39], v[108:111], v[148:151]
    ds_read_b128 v[76:79], v21 offset:2048
    v_mfma_f32_16x16x32_bf16 v[152:155], v[32:35], v[112:115], v[152:155]
    ds_read_b128 v[80:83], v20 offset:4096
    v_mfma_f32_16x16x32_bf16 v[152:155], v[36:39], v[116:119], v[152:155]
    ds_read_b128 v[84:87], v21 offset:4096
    v_mfma_f32_16x16x32_bf16 v[184:187], v[40:43], v[112:115], v[184:187]
    ds_read_b128 v[88:91], v20 offset:6144
    v_mfma_f32_16x16x32_bf16 v[184:187], v[44:47], v[116:119], v[184:187]
    ds_read_b128 v[92:95], v21 offset:6144
    v_mfma_f32_16x16x32_bf16 v[216:219], v[48:51], v[112:115], v[216:219]
    ds_read_b128 v[104:107], v22 offset:512
    v_mfma_f32_16x16x32_bf16 v[216:219], v[52:55], v[116:119], v[216:219]
    ds_read_b128 v[108:111], v22 offset:8704
    v_mfma_f32_16x16x32_bf16 v[248:251], v[56:59], v[112:115], v[248:251]
    v_mfma_f32_16x16x32_bf16 v[248:251], v[60:63], v[116:119], v[248:251]
    v_mfma_f32_16x16x32_bf16 v[252:255], v[56:59], v[120:123], v[252:255]
    ds_read_b128 v[112:115], v22 offset:1024
    v_mfma_f32_16x16x32_bf16 v[252:255], v[60:63], v[124:127], v[252:255]
    ds_read_b128 v[116:119], v22 offset:9216
    v_mfma_f32_16x16x32_bf16 v[220:223], v[48:51], v[120:123], v[220:223]
    v_mfma_f32_16x16x32_bf16 v[220:223], v[52:55], v[124:127], v[220:223]
    v_mfma_f32_16x16x32_bf16 v[188:191], v[40:43], v[120:123], v[188:191]
    v_mfma_f32_16x16x32_bf16 v[188:191], v[44:47], v[124:127], v[188:191]
    v_mfma_f32_16x16x32_bf16 v[156:159], v[32:35], v[120:123], v[156:159]
    v_mfma_f32_16x16x32_bf16 v[156:159], v[36:39], v[124:127], v[156:159]
    s_waitcnt lgkmcnt(10)
    v_mfma_f32_16x16x32_bf16 v[128:131], v[64:67], v[96:99], v[128:131]
    ds_read_b128 v[120:123], v22 offset:1536
    v_mfma_f32_16x16x32_bf16 v[128:131], v[68:71], v[100:103], v[128:131]
    ds_read_b128 v[124:127], v22 offset:9728
    s_waitcnt lgkmcnt(10)
    v_mfma_f32_16x16x32_bf16 v[160:163], v[72:75], v[96:99], v[160:163]
    v_mfma_f32_16x16x32_bf16 v[160:163], v[76:79], v[100:103], v[160:163]
    s_add_u32 s32, s32, 49152
    s_waitcnt lgkmcnt(8)
    v_mfma_f32_16x16x32_bf16 v[192:195], v[80:83], v[96:99], v[192:195]
    v_mfma_f32_16x16x32_bf16 v[192:195], v[84:87], v[100:103], v[192:195]
    s_cmp_eq_u32 s32, 147456
    s_waitcnt lgkmcnt(6)
    v_mfma_f32_16x16x32_bf16 v[224:227], v[88:91], v[96:99], v[224:227]
    v_mfma_f32_16x16x32_bf16 v[224:227], v[92:95], v[100:103], v[224:227]
    s_cselect_b32 s32, 0, s32
    s_waitcnt lgkmcnt(4)
    v_mfma_f32_16x16x32_bf16 v[228:231], v[88:91], v[104:107], v[228:231]
    ds_read_b128 v[96:99], v23 offset:0
    v_mfma_f32_16x16x32_bf16 v[228:231], v[92:95], v[108:111], v[228:231]
    ds_read_b128 v[100:103], v23 offset:8192
    v_mfma_f32_16x16x32_bf16 v[196:199], v[80:83], v[104:107], v[196:199]
    v_mfma_f32_16x16x32_bf16 v[196:199], v[84:87], v[108:111], v[196:199]
    v_mfma_f32_16x16x32_bf16 v[164:167], v[72:75], v[104:107], v[164:167]
    v_mfma_f32_16x16x32_bf16 v[164:167], v[76:79], v[108:111], v[164:167]
    v_mfma_f32_16x16x32_bf16 v[132:135], v[64:67], v[104:107], v[132:135]
    v_mfma_f32_16x16x32_bf16 v[132:135], v[68:71], v[108:111], v[132:135]
    s_waitcnt lgkmcnt(4)
    v_mfma_f32_16x16x32_bf16 v[136:139], v[64:67], v[112:115], v[136:139]
    ds_read_b128 v[104:107], v23 offset:512
    v_mfma_f32_16x16x32_bf16 v[136:139], v[68:71], v[116:119], v[136:139]
    ds_read_b128 v[108:111], v23 offset:8704
    v_mfma_f32_16x16x32_bf16 v[168:171], v[72:75], v[112:115], v[168:171]
    v_mfma_f32_16x16x32_bf16 v[168:171], v[76:79], v[116:119], v[168:171]
    v_mfma_f32_16x16x32_bf16 v[200:203], v[80:83], v[112:115], v[200:203]
    v_mfma_f32_16x16x32_bf16 v[200:203], v[84:87], v[116:119], v[200:203]
    v_mfma_f32_16x16x32_bf16 v[232:235], v[88:91], v[112:115], v[232:235]
    v_mfma_f32_16x16x32_bf16 v[232:235], v[92:95], v[116:119], v[232:235]
    s_waitcnt lgkmcnt(4)
    v_mfma_f32_16x16x32_bf16 v[236:239], v[88:91], v[120:123], v[236:239]
    ds_read_b128 v[112:115], v23 offset:1024
    v_mfma_f32_16x16x32_bf16 v[236:239], v[92:95], v[124:127], v[236:239]
    ds_read_b128 v[116:119], v23 offset:9216
    v_mfma_f32_16x16x32_bf16 v[204:207], v[80:83], v[120:123], v[204:207]
    v_mfma_f32_16x16x32_bf16 v[204:207], v[84:87], v[124:127], v[204:207]
    v_mfma_f32_16x16x32_bf16 v[172:175], v[72:75], v[120:123], v[172:175]
    v_mfma_f32_16x16x32_bf16 v[172:175], v[76:79], v[124:127], v[172:175]
    v_mfma_f32_16x16x32_bf16 v[140:143], v[64:67], v[120:123], v[140:143]
    v_mfma_f32_16x16x32_bf16 v[140:143], v[68:71], v[124:127], v[140:143]
    s_waitcnt lgkmcnt(4)
    v_mfma_f32_16x16x32_bf16 v[144:147], v[64:67], v[96:99], v[144:147]
    ds_read_b128 v[120:123], v23 offset:1536
    v_mfma_f32_16x16x32_bf16 v[144:147], v[68:71], v[100:103], v[144:147]
    ds_read_b128 v[124:127], v23 offset:9728
    v_add_u32 v22, s32, v18
    v_mfma_f32_16x16x32_bf16 v[176:179], v[72:75], v[96:99], v[176:179]
    v_add_u32 v20, s32, v16
    v_add_u32 v21, s32, v17
    v_mfma_f32_16x16x32_bf16 v[176:179], v[76:79], v[100:103], v[176:179]
    v_add_u32 v23, s32, v19
    v_mfma_f32_16x16x32_bf16 v[208:211], v[80:83], v[96:99], v[208:211]
    v_mfma_f32_16x16x32_bf16 v[208:211], v[84:87], v[100:103], v[208:211]
    v_mfma_f32_16x16x32_bf16 v[240:243], v[88:91], v[96:99], v[240:243]
    v_mfma_f32_16x16x32_bf16 v[240:243], v[92:95], v[100:103], v[240:243]
    s_waitcnt lgkmcnt(4)
    v_mfma_f32_16x16x32_bf16 v[244:247], v[88:91], v[104:107], v[244:247]
    v_mfma_f32_16x16x32_bf16 v[244:247], v[92:95], v[108:111], v[244:247]
    s_waitcnt lgkmcnt(0)
    s_barrier
    v_mfma_f32_16x16x32_bf16 v[212:215], v[80:83], v[104:107], v[212:215]
    ds_read_b128 v[96:99], v22 offset:0
    v_mfma_f32_16x16x32_bf16 v[212:215], v[84:87], v[108:111], v[212:215]
    ds_read_b128 v[32:35], v20 offset:0
    v_mfma_f32_16x16x32_bf16 v[180:183], v[72:75], v[104:107], v[180:183]
    ds_read_b128 v[100:103], v22 offset:8192
    v_mfma_f32_16x16x32_bf16 v[180:183], v[76:79], v[108:111], v[180:183]
    ds_read_b128 v[36:39], v21 offset:0
    v_mfma_f32_16x16x32_bf16 v[148:151], v[64:67], v[104:107], v[148:151]
    ds_read_b128 v[40:43], v20 offset:2048
    v_mfma_f32_16x16x32_bf16 v[148:151], v[68:71], v[108:111], v[148:151]
    ds_read_b128 v[44:47], v21 offset:2048
    v_mfma_f32_16x16x32_bf16 v[152:155], v[64:67], v[112:115], v[152:155]
    ds_read_b128 v[48:51], v20 offset:4096
    v_mfma_f32_16x16x32_bf16 v[152:155], v[68:71], v[116:119], v[152:155]
    ds_read_b128 v[52:55], v21 offset:4096
    v_mfma_f32_16x16x32_bf16 v[184:187], v[72:75], v[112:115], v[184:187]
    ds_read_b128 v[56:59], v20 offset:6144
    v_mfma_f32_16x16x32_bf16 v[184:187], v[76:79], v[116:119], v[184:187]
    ds_read_b128 v[60:63], v21 offset:6144
    v_mfma_f32_16x16x32_bf16 v[216:219], v[80:83], v[112:115], v[216:219]
    ds_read_b128 v[104:107], v22 offset:512
    v_mfma_f32_16x16x32_bf16 v[216:219], v[84:87], v[116:119], v[216:219]
    ds_read_b128 v[108:111], v22 offset:8704
    v_mfma_f32_16x16x32_bf16 v[248:251], v[88:91], v[112:115], v[248:251]
    v_mfma_f32_16x16x32_bf16 v[248:251], v[92:95], v[116:119], v[248:251]
    v_mfma_f32_16x16x32_bf16 v[252:255], v[88:91], v[120:123], v[252:255]
    ds_read_b128 v[112:115], v22 offset:1024
    v_mfma_f32_16x16x32_bf16 v[252:255], v[92:95], v[124:127], v[252:255]
    ds_read_b128 v[116:119], v22 offset:9216
    v_mfma_f32_16x16x32_bf16 v[220:223], v[80:83], v[120:123], v[220:223]
    v_mfma_f32_16x16x32_bf16 v[220:223], v[84:87], v[124:127], v[220:223]
    s_sub_u32 s33, s33, 2
    v_mfma_f32_16x16x32_bf16 v[188:191], v[72:75], v[120:123], v[188:191]
    v_mfma_f32_16x16x32_bf16 v[188:191], v[76:79], v[124:127], v[188:191]
    s_cmp_lg_u32 s33, 0
    v_mfma_f32_16x16x32_bf16 v[156:159], v[64:67], v[120:123], v[156:159]
    v_mfma_f32_16x16x32_bf16 v[156:159], v[68:71], v[124:127], v[156:159]
    s_cbranch_scc1 L_cloop
    s_waitcnt lgkmcnt(10)
    v_mfma_f32_16x16x32_bf16 v[128:131], v[32:35], v[96:99], v[128:131]
    ds_read_b128 v[120:123], v22 offset:1536
    v_mfma_f32_16x16x32_bf16 v[128:131], v[36:39], v[100:103], v[128:131]
    ds_read_b128 v[124:127], v22 offset:9728
    s_waitcnt lgkmcnt(10)
    v_mfma_f32_16x16x32_bf16 v[160:163], v[40:43], v[96:99], v[160:163]
    v_mfma_f32_16x16x32_bf16 v[160:163], v[44:47], v[100:103], v[160:163]
    s_waitcnt lgkmcnt(4)
    v_mfma_f32_16x16x32_bf16 v[164:167], v[40:43], v[104:107], v[164:167]
    ds_read_b128 v[96:99], v23 offset:0
    v_mfma_f32_16x16x32_bf16 v[164:167], v[44:47], v[108:111], v[164:167]
    ds_read_b128 v[100:103], v23 offset:8192
    v_mfma_f32_16x16x32_bf16 v[132:135], v[32:35], v[104:107], v[132:135]
    v_mfma_f32_16x16x32_bf16 v[132:135], v[36:39], v[108:111], v[132:135]
    s_waitcnt lgkmcnt(4)
    v_mfma_f32_16x16x32_bf16 v[136:139], v[32:35], v[112:115], v[136:139]
    ds_read_b128 v[104:107], v23 offset:512
    v_mfma_f32_16x16x32_bf16 v[136:139], v[36:39], v[116:119], v[136:139]
    ds_read_b128 v[108:111], v23 offset:8704
    v_mfma_f32_16x16x32_bf16 v[168:171], v[40:43], v[112:115], v[168:171]
    v_mfma_f32_16x16x32_bf16 v[168:171], v[44:47], v[116:119], v[168:171]
    s_waitcnt lgkmcnt(4)
    v_mfma_f32_16x16x32_bf16 v[172:175], v[40:43], v[120:123], v[172:175]
    ds_read_b128 v[112:115], v23 offset:1024
    v_mfma_f32_16x16x32_bf16 v[172:175], v[44:47], v[124:127], v[172:175]
    ds_read_b128 v[116:119], v23 offset:9216
    v_mfma_f32_16x16x32_bf16 v[140:143], v[32:35], v[120:123], v[140:143]
    v_mfma_f32_16x16x32_bf16 v[140:143], v[36:39], v[124:127], v[140:143]
    s_waitcnt lgkmcnt(4)
    v_mfma_f32_16x16x32_bf16 v[144:147], v[32:35], v[96:99], v[144:147]
    ds_read_b128 v[120:123], v23 offset:1536
    v_mfma_f32_16x16x32_bf16 v[144:147], v[36:39], v[100:103], v[144:147]
    ds_read_b128 v[124:127], v23 offset:9728
    v_add_u32 v22, 98304, v18
    v_mfma_f32_16x16x32_bf16 v[176:179], v[40:43], v[96:99], v[176:179]
    v_add_u32 v20, 98304, v16
    v_add_u32 v21, 98304, v17
    v_mfma_f32_16x16x32_bf16 v[176:179], v[44:47], v[100:103], v[176:179]
    v_add_u32 v23, 98304, v19
    s_barrier
    s_waitcnt lgkmcnt(4)
    v_mfma_f32_16x16x32_bf16 v[180:183], v[40:43], v[104:107], v[180:183]
    ds_read_b128 v[96:99], v22 offset:0
    v_mfma_f32_16x16x32_bf16 v[180:183], v[44:47], v[108:111], v[180:183]
    ds_read_b128 v[64:67], v20 offset:0
    v_mfma_f32_16x16x32_bf16 v[148:151], v[32:35], v[104:107], v[148:151]
    ds_read_b128 v[100:103], v22 offset:8192
    v_mfma_f32_16x16x32_bf16 v[148:151], v[36:39], v[108:111], v[148:151]
    ds_read_b128 v[68:71], v21 offset:0
    s_waitcnt lgkmcnt(6)
    v_mfma_f32_16x16x32_bf16 v[152:155], v[32:35], v[112:115], v[152:155]
    ds_read_b128 v[72:75], v20 offset:2048
    v_mfma_f32_16x16x32_bf16 v[152:155], v[36:39], v[116:119], v[152:155]
    ds_read_b128 v[76:79], v21 offset:2048
    v_mfma_f32_16x16x32_bf16 v[184:187], v[40:43], v[112:115], v[184:187]
    ds_read_b128 v[104:107], v22 offset:512
    v_mfma_f32_16x16x32_bf16 v[184:187], v[44:47], v[116:119], v[184:187]
    ds_read_b128 v[108:111], v22 offset:8704
    s_waitcnt lgkmcnt(8)
    v_mfma_f32_16x16x32_bf16 v[188:191], v[40:43], v[120:123], v[188:191]
    ds_read_b128 v[112:115], v22 offset:1024
    v_mfma_f32_16x16x32_bf16 v[188:191], v[44:47], v[124:127], v[188:191]
    ds_read_b128 v[116:119], v22 offset:9216
    v_mfma_f32_16x16x32_bf16 v[156:159], v[32:35], v[120:123], v[156:159]
    v_mfma_f32_16x16x32_bf16 v[156:159], v[36:39], v[124:127], v[156:159]
    s_waitcnt lgkmcnt(6)
    v_mfma_f32_16x16x32_bf16 v[128:131], v[64:67], v[96:99], v[128:131]
    ds_read_b128 v[120:123], v22 offset:1536
    v_mfma_f32_16x16x32_bf16 v[128:131], v[68:71], v[100:103], v[128:131]
    ds_read_b128 v[124:127], v22 offset:9728
    s_waitcnt lgkmcnt(6)
    v_mfma_f32_16x16x32_bf16 v[160:163], v[72:75], v[96:99], v[160:163]
    v_mfma_f32_16x16x32_bf16 v[160:163], v[76:79], v[100:103], v[160:163]
    s_waitcnt lgkmcnt(4)
    v_mfma_f32_16x16x32_bf16 v[164:167], v[72:75], v[104:107], v[164:167]
    ds_read_b128 v[96:99], v23 offset:0
    v_mfma_f32_16x16x32_bf16 v[164:167], v[76:79], v[108:111], v[164:167]
    ds_read_b128 v[100:103], v23 offset:8192
    v_mfma_f32_16x16x32_bf16 v[132:135], v[64:67], v[104:107], v[132:135]
    v_mfma_f32_16x16x32_bf16 v[132:135], v[68:71], v[108:111], v[132:135]
    s_waitcnt lgkmcnt(4)
    v_mfma_f32_16x16x32_bf16 v[136:139], v[64:67], v[112:115], v[136:139]
    ds_read_b128 v[104:107], v23 offset:512
    v_mfma_f32_16x16x32_bf16 v[136:139], v[68:71], v[116:119], v[136:139]
    ds_read_b128 v[108:111], v23 offset:8704
    v_mfma_f32_16x16x32_bf16 v[168:171], v[72:75], v[112:115], v[168:171]
    v_mfma_f32_16x16x32_bf16 v[168:171], v[76:79], v[116:119], v[168:171]
    s_waitcnt lgkmcnt(4)
    v_mfma_f32_16x16x32_bf16 v[172:175], v[72:75], v[120:123], v[172:175]
    ds_read_b128 v[112:115], v23 offset:1024
    v_mfma_f32_16x16x32_bf16 v[172:175], v[76:79], v[124:127], v[172:175]
    ds_read_b128 v[116:119], v23 offset:9216
    v_mfma_f32_16x16x32_bf16 v[140:143], v[64:67], v[120:123], v[140:143]
    v_mfma_f32_16x16x32_bf16 v[140:143], v[68:71], v[124:127], v[140:143]
    s_waitcnt lgkmcnt(4)
    v_mfma_f32_16x16x32_bf16 v[144:147], v[64:67], v[96:99], v[144:147]
    ds_read_b128 v[120:123], v23 offset:1536
    v_mfma_f32_16x16x32_bf16 v[144:147], v[68:71], v[100:103], v[144:147]
    ds_read_b128 v[124:127], v23 offset:9728
    v_add_u32 v22, 0, v18
    v_mfma_f32_16x16x32_bf16 v[176:179], v[72:75], v[96:99], v[176:179]
    v_add_u32 v20, 0, v16
    v_add_u32 v21, 0, v17
    v_mfma_f32_16x16x32_bf16 v[176:179], v[76:79], v[100:103], v[176:179]
    v_add_u32 v23, 0, v19
    s_barrier
    s_waitcnt lgkmcnt(4)
    v_mfma_f32_16x16x32_bf16 v[180:183], v[72:75], v[104:107], v[180:183]
    ds_read_b128 v[96:99], v22 offset:0
    v_mfma_f32_16x16x32_bf16 v[180:183], v[76:79], v[108:111], v[180:183]
    ds_read_b128 v[32:35], v20 offset:0
    v_mfma_f32_16x16x32_bf16 v[148:151], v[64:67], v[104:107], v[148:151]
    ds_read_b128 v[100:103], v22 offset:8192
    v_mfma_f32_16x16x32_bf16 v[148:151], v[68:71], v[108:111], v[148:151]
    ds_read_b128 v[36:39], v21 offset:0
    s_waitcnt lgkmcnt(6)
    v_mfma_f32_16x16x32_bf16 v[152:155], v[64:67], v[112:115], v[152:155]
    ds_read_b128 v[40:43], v20 offset:2048
    v_mfma_f32_16x16x32_bf16 v[152:155], v[68:71], v[116:119], v[152:155]
    ds_read_b128 v[44:47], v21 offset:2048
    v_mfma_f32_16x16x32_bf16 v[184:187], v[72:75], v[112:115], v[184:187]
    ds_read_b128 v[104:107], v22 offset:512
    v_mfma_f32_16x16x32_bf16 v[184:187], v[76:79], v[116:119], v[184:187]
    ds_read_b128 v[108:111], v22 offset:8704
    s_waitcnt lgkmcnt(8)
    v_mfma_f32_16x16x32_bf16 v[188:191], v[72:75], v[120:123], v[188:191]
    ds_read_b128 v[112:115], v22 offset:1024
    v_mfma_f32_16x16x32_bf16 v[188:191], v[76:79], v[124:127], v[188:191]
    ds_read_b128 v[116:119], v22 offset:9216
    v_mfma_f32_16x16x32_bf16 v[156:159], v[64:67], v[120:123], v[156:159]
    v_mfma_f32_16x16x32_bf16 v[156:159], v[68:71], v[124:127], v[156:159]
    s_waitcnt lgkmcnt(6)
    v_mfma_f32_16x16x32_bf16 v[128:131], v[32:35], v[96:99], v[128:131]
    ds_read_b128 v[120:123], v22 offset:1536
    v_mfma_f32_16x16x32_bf16 v[128:131], v[36:39], v[100:103], v[128:131]
    ds_read_b128 v[124:127], v22 offset:9728
    s_waitcnt lgkmcnt(6)
    v_mfma_f32_16x16x32_bf16 v[160:163], v[40:43], v[96:99], v[160:163]
    v_mfma_f32_16x16x32_bf16 v[160:163], v[44:47], v[100:103], v[160:163]
    s_waitcnt lgkmcnt(4)
    v_mfma_f32_16x16x32_bf16 v[164:167], v[40:43], v[104:107], v[164:167]
    ds_read_b128 v[96:99], v23 offset:0
    v_mfma_f32_16x16x32_bf16 v[164:167], v[44:47], v[108:111], v[164:167]
    ds_read_b128 v[100:103], v23 offset:8192
    v_mfma_f32_16x16x32_bf16 v[132:135], v[32:35], v[104:107], v[132:135]
    v_mfma_f32_16x16x32_bf16 v[132:135], v[36:39], v[108:111], v[132:135]
    s_waitcnt lgkmcnt(4)
    v_mfma_f32_16x16x32_bf16 v[136:139], v[32:35], v[112:115], v[136:139]
    ds_read_b128 v[104:107], v23 offset:512
    v_mfma_f32_16x16x32_bf16 v[136:139], v[36:39], v[116:119], v[136:139]
    ds_read_b128 v[108:111], v23 offset:8704
    v_mfma_f32_16x16x32_bf16 v[168:171], v[40:43], v[112:115], v[168:171]
    v_mfma_f32_16x16x32_bf16 v[168:171], v[44:47], v[116:119], v[168:171]
    s_waitcnt lgkmcnt(4)
    v_mfma_f32_16x16x32_bf16 v[172:175], v[40:43], v[120:123], v[172:175]
    ds_read_b128 v[112:115], v23 offset:1024
    v_mfma_f32_16x16x32_bf16 v[172:175], v[44:47], v[124:127], v[172:175]
    ds_read_b128 v[116:119], v23 offset:9216
    v_mfma_f32_16x16x32_bf16 v[140:143], v[32:35], v[120:123], v[140:143]
    v_mfma_f32_16x16x32_bf16 v[140:143], v[36:39], v[124:127], v[140:143]
    s_waitcnt lgkmcnt(4)
    v_mfma_f32_16x16x32_bf16 v[144:147], v[32:35], v[96:99], v[144:147]
    ds_read_b128 v[120:123], v23 offset:1536
    v_mfma_f32_16x16x32_bf16 v[144:147], v[36:39], v[100:103], v[144:147]
    ds_read_b128 v[124:127], v23 offset:9728
    v_add_u32 v22, 49152, v18
    v_mfma_f32_16x16x32_bf16 v[176:179], v[40:43], v[96:99], v[176:179]
    v_add_u32 v20, 49152, v16
    v_add_u32 v21, 49152, v17
    v_mfma_f32_16x16x32_bf16 v[176:179], v[44:47], v[100:103], v[176:179]
    v_add_u32 v23, 49152, v19
    s_barrier
    s_waitcnt lgkmcnt(4)
    v_mfma_f32_16x16x32_bf16 v[180:183], v[40:43], v[104:107], v[180:183]
    ds_read_b128 v[96:99], v22 offset:0
    v_mfma_f32_16x16x32_bf16 v[180:183], v[44:47], v[108:111], v[180:183]
    ds_read_b128 v[64:67], v20 offset:4096
    v_mfma_f32_16x16x32_bf16 v[148:151], v[32:35], v[104:107], v[148:151]
    ds_read_b128 v[100:103], v22 offset:8192
    v_mfma_f32_16x16x32_bf16 v[148:151], v[36:39], v[108:111], v[148:151]
    ds_read_b128 v[68:71], v21 offset:4096
    s_waitcnt lgkmcnt(6)
    v_mfma_f32_16x16x32_bf16 v[152:155], v[32:35], v[112:115], v[152:155]
    ds_read_b128 v[72:75], v20 offset:6144
    v_mfma_f32_16x16x32_bf16 v[152:155], v[36:39], v[116:119], v[152:155]
    ds_read_b128 v[76:79], v21 offset:6144
    v_mfma_f32_16x16x32_bf16 v[184:187], v[40:43], v[112:115], v[184:187]
    ds_read_b128 v[104:107], v22 offset:512
    v_mfma_f32_16x16x32_bf16 v[184:187], v[44:47], v[116:119], v[184:187]
    ds_read_b128 v[108:111], v22 offset:8704
    s_waitcnt lgkmcnt(8)
    v_mfma_f32_16x16x32_bf16 v[188:191], v[40:43], v[120:123], v[188:191]
    ds_read_b128 v[112:115], v22 offset:1024
    v_mfma_f32_16x16x32_bf16 v[188:191], v[44:47], v[124:127], v[188:191]
    ds_read_b128 v[116:119], v22 offset:9216
    v_mfma_f32_16x16x32_bf16 v[156:159], v[32:35], v[120:123], v[156:159]
    v_mfma_f32_16x16x32_bf16 v[156:159], v[36:39], v[124:127], v[156:159]
    s_waitcnt lgkmcnt(6)
    v_mfma_f32_16x16x32_bf16 v[192:195], v[64:67], v[96:99], v[192:195]
    ds_read_b128 v[120:123], v22 offset:1536
    v_mfma_f32_16x16x32_bf16 v[192:195], v[68:71], v[100:103], v[192:195]
    ds_read_b128 v[124:127], v22 offset:9728
    s_waitcnt lgkmcnt(6)
    v_mfma_f32_16x16x32_bf16 v[224:227], v[72:75], v[96:99], v[224:227]
    v_mfma_f32_16x16x32_bf16 v[224:227], v[76:79], v[100:103], v[224:227]
    s_waitcnt lgkmcnt(4)
    v_mfma_f32_16x16x32_bf16 v[228:231], v[72:75], v[104:107], v[228:231]
    ds_read_b128 v[96:99], v23 offset:0
    v_cvt_pk_bf16_f32 v48, v128, v132
    v_mfma_f32_16x16x32_bf16 v[228:231], v[76:79], v[108:111], v[228:231]
    ds_read_b128 v[100:103], v23 offset:8192
    v_cvt_pk_bf16_f32 v49, v136, v140
    v_mfma_f32_16x16x32_bf16 v[196:199], v[64:67], v[104:107], v[196:199]
    v_cvt_pk_bf16_f32 v50, v144, v148
    v_cvt_pk_bf16_f32 v51, v152, v156
    v_mfma_f32_16x16x32_bf16 v[196:199], v[68:71], v[108:111], v[196:199]
    s_add_u32 s34, s29, 0
    s_waitcnt lgkmcnt(4)
    v_mfma_f32_16x16x32_bf16 v[200:203], v[64:67], v[112:115], v[200:203]
    ds_read_b128 v[104:107], v23 offset:512
    buffer_store_dwordx4 v[48:51], v24, s[36:39], s34 offen nt
    v_mfma_f32_16x16x32_bf16 v[200:203], v[68:71], v[116:119], v[200:203]
    ds_read_b128 v[108:111], v23 offset:8704
    v_cvt_pk_bf16_f32 v52, v129, v133
    v_mfma_f32_16x16x32_bf16 v[232:235], v[72:75], v[112:115], v[232:235]
    v_cvt_pk_bf16_f32 v53, v137, v141
    v_cvt_pk_bf16_f32 v54, v145, v149
    v_mfma_f32_16x16x32_bf16 v[232:235], v[76:79], v[116:119], v[232:235]
    v_cvt_pk_bf16_f32 v55, v153, v157
    s_waitcnt lgkmcnt(4)
    v_mfma_f32_16x16x32_bf16 v[236:239], v[72:75], v[120:123], v[236:239]
    ds_read_b128 v[112:115], v23 offset:1024
    s_add_u32 s34, s29, 7168
    v_mfma_f32_16x16x32_bf16 v[236:239], v[76:79], v[124:127], v[236:239]
    ds_read_b128 v[116:119], v23 offset:9216
    buffer_store_dwordx4 v[52:55], v24, s[36:39], s34 offen nt
    v_mfma_f32_16x16x32_bf16 v[204:207], v[64:67], v[120:123], v[204:207]
    v_cvt_pk_bf16_f32 v56, v130, v134
    v_cvt_pk_bf16_f32 v57, v138, v142
    v_mfma_f32_16x16x32_bf16 v[204:207], v[68:71], v[124:127], v[204:207]
    v_cvt_pk_bf16_f32 v58, v146, v150
    s_waitcnt lgkmcnt(4)
    v_mfma_f32_16x16x32_bf16 v[208:211], v[64:67], v[96:99], v[208:211]
    ds_read_b128 v[120:123], v23 offset:1536
    v_cvt_pk_bf16_f32 v59, v154, v158
    v_mfma_f32_16x16x32_bf16 v[208:211], v[68:71], v[100:103], v[208:211]
    ds_read_b128 v[124:127], v23 offset:9728
    v_add_u32 v22, 98304, v18
    v_mfma_f32_16x16x32_bf16 v[240:243], v[72:75], v[96:99], v[240:243]
    v_add_u32 v20, 98304, v16
    v_add_u32 v21, 98304, v17
    v_mfma_f32_16x16x32_bf16 v[240:243], v[76:79], v[100:103], v[240:243]
    v_add_u32 v23, 98304, v19
    s_waitcnt lgkmcnt(4)
    v_mfma_f32_16x16x32_bf16 v[244:247], v[72:75], v[104:107], v[244:247]
    ds_read_b128 v[96:99], v22 offset:0
    s_add_u32 s34, s29, 14336
    v_mfma_f32_16x16x32_bf16 v[244:247], v[76:79], v[108:111], v[244:247]
    ds_read_b128 v[32:35], v20 offset:4096
    buffer_store_dwordx4 v[56:59], v24, s[36:39], s34 offen nt
    v_mfma_f32_16x16x32_bf16 v[212:215], v[64:67], v[104:107], v[212:215]
    ds_read_b128 v[100:103], v22 offset:8192
    v_cvt_pk_bf16_f32 v60, v131, v135
    v_mfma_f32_16x16x32_bf16 v[212:215], v[68:71], v[108:111], v[212:215]
    ds_read_b128 v[36:39], v21 offset:4096
    s_waitcnt lgkmcnt(6)
    v_mfma_f32_16x16x32_bf16 v[216:219], v[64:67], v[112:115], v[216:219]
    ds_read_b128 v[40:43], v20 offset:6144
    v_cvt_pk_bf16_f32 v61, v139, v143
    v_mfma_f32_16x16x32_bf16 v[216:219], v[68:71], v[116:119], v[216:219]
    ds_read_b128 v[44:47], v21 offset:6144
    v_cvt_pk_bf16_f32 v62, v147, v151
    v_mfma_f32_16x16x32_bf16 v[248:251], v[72:75], v[112:115], v[248:251]
    ds_read_b128 v[104:107], v22 offset:512
    v_cvt_pk_bf16_f32 v63, v155, v159
    v_mfma_f32_16x16x32_bf16 v[248:251], v[76:79], v[116:119], v[248:251]
    ds_read_b128 v[108:111], v22 offset:8704
    s_waitcnt lgkmcnt(8)
    v_mfma_f32_16x16x32_bf16 v[252:255], v[72:75], v[120:123], v[252:255]
    ds_read_b128 v[112:115], v22 offset:1024
    s_add_u32 s34, s29, 21504
    v_mfma_f32_16x16x32_bf16 v[252:255], v[76:79], v[124:127], v[252:255]
    ds_read_b128 v[116:119], v22 offset:9216
    buffer_store_dwordx4 v[60:63], v24, s[36:39], s34 offen nt
    v_mfma_f32_16x16x32_bf16 v[220:223], v[64:67], v[120:123], v[220:223]
    v_cvt_pk_bf16_f32 v80, v160, v164
    v_cvt_pk_bf16_f32 v81, v168, v172
    v_mfma_f32_16x16x32_bf16 v[220:223], v[68:71], v[124:127], v[220:223]
    v_cvt_pk_bf16_f32 v82, v176, v180
    s_waitcnt lgkmcnt(6)
    v_mfma_f32_16x16x32_bf16 v[192:195], v[32:35], v[96:99], v[192:195]
    ds_read_b128 v[120:123], v22 offset:1536
    v_cvt_pk_bf16_f32 v83, v184, v188
    v_mfma_f32_16x16x32_bf16 v[192:195], v[36:39], v[100:103], v[192:195]
    ds_read_b128 v[124:127], v22 offset:9728
    s_add_u32 s34, s29, 114688
    s_waitcnt lgkmcnt(6)
    v_mfma_f32_16x16x32_bf16 v[224:227], v[40:43], v[96:99], v[224:227]
    ds_read_b128 v[128:131], v19 offset:0
    buffer_store_dwordx4 v[80:83], v24, s[36:39], s34 offen nt
    v_mfma_f32_16x16x32_bf16 v[224:227], v[44:47], v[100:103], v[224:227]
    ds_read_b128 v[132:135], v19 offset:8192
    s_waitcnt lgkmcnt(6)
    v_mfma_f32_16x16x32_bf16 v[228:231], v[40:43], v[104:107], v[228:231]
    ds_read_b128 v[96:99], v23 offset:0
    v_cvt_pk_bf16_f32 v84, v161, v165
    v_mfma_f32_16x16x32_bf16 v[228:231], v[44:47], v[108:111], v[228:231]
    ds_read_b128 v[100:103], v23 offset:8192
    v_cvt_pk_bf16_f32 v85, v169, v173
    v_mfma_f32_16x16x32_bf16 v[196:199], v[32:35], v[104:107], v[196:199]
    ds_read_b128 v[136:139], v19 offset:512
    v_cvt_pk_bf16_f32 v86, v177, v181
    v_mfma_f32_16x16x32_bf16 v[196:199], v[36:39], v[108:111], v[196:199]
    ds_read_b128 v[140:143], v19 offset:8704
    s_waitcnt lgkmcnt(8)
    v_mfma_f32_16x16x32_bf16 v[200:203], v[32:35], v[112:115], v[200:203]
    ds_read_b128 v[104:107], v23 offset:512
    v_cvt_pk_bf16_f32 v87, v185, v189
    v_mfma_f32_16x16x32_bf16 v[200:203], v[36:39], v[116:119], v[200:203]
    ds_read_b128 v[108:111], v23 offset:8704
    s_add_u32 s34, s29, 121856
    v_mfma_f32_16x16x32_bf16 v[232:235], v[40:43], v[112:115], v[232:235]
L_stub:
    s_cbranch_execz L_stubr
    ds_read_b128 v[144:147], v19 offset:1024
    buffer_store_dwordx4 v[84:87], v24, s[36:39], s34 offen nt
    v_mfma_f32_16x16x32_bf16 v[232:235], v[44:47], v[116:119], v[232:235]
    ds_read_b128 v[148:151], v19 offset:9216
    s_waitcnt lgkmcnt(10)
    v_mfma_f32_16x16x32_bf16 v[236:239], v[40:43], v[120:123], v[236:239]
    ds_read_b128 v[112:115], v23 offset:1024
    v_cvt_pk_bf16_f32 v88, v162, v166
    v_mfma_f32_16x16x32_bf16 v[236:239], v[44:47], v[124:127], v[236:239]
    ds_read_b128 v[116:119], v23 offset:9216
    v_cvt_pk_bf16_f32 v89, v170, v174
    v_mfma_f32_16x16x32_bf16 v[204:207], v[32:35], v[120:123], v[204:207]
    ds_read_b128 v[152:155], v19 offset:1536
    v_cvt_pk_bf16_f32 v90, v178, v182
    v_mfma_f32_16x16x32_bf16 v[204:207], v[36:39], v[124:127], v[204:207]
    ds_read_b128 v[156:159], v19 offset:9728
    s_waitcnt lgkmcnt(10)
    v_mfma_f32_16x16x32_bf16 v[208:211], v[32:35], v[96:99], v[208:211]
    ds_read_b128 v[120:123], v23 offset:1536
    v_cvt_pk_bf16_f32 v91, v186, v190
    v_mfma_f32_16x16x32_bf16 v[208:211], v[36:39], v[100:103], v[208:211]
    ds_read_b128 v[124:127], v23 offset:9728
    v_add_u32 v22, 0, v18
    v_mfma_f32_16x16x32_bf16 v[240:243], v[40:43], v[96:99], v[240:243]
    v_add_u32 v20, 0, v16
    v_add_u32 v21, 0, v17
    v_mfma_f32_16x16x32_bf16 v[240:243], v[44:47], v[100:103], v[240:243]
    v_add_u32 v23, 0, v19
    s_waitcnt lgkmcnt(8)
    v_mfma_f32_16x16x32_bf16 v[244:247], v[40:43], v[104:107], v[244:247]
    ds_read_b128 v[96:99], v22 offset:0
    s_add_u32 s34, s29, 129024
    v_mfma_f32_16x16x32_bf16 v[244:247], v[44:47], v[108:111], v[244:247]
    ds_read_b128 v[64:67], v20 offset:4096
    buffer_store_dwordx4 v[88:91], v24, s[36:39], s34 offen nt
    v_mfma_f32_16x16x32_bf16 v[212:215], v[32:35], v[104:107], v[212:215]
    ds_read_b128 v[100:103], v22 offset:8192
    v_cvt_pk_bf16_f32 v92, v163, v167
    v_mfma_f32_16x16x32_bf16 v[212:215], v[36:39], v[108:111], v[212:215]
    ds_read_b128 v[68:71], v21 offset:4096
    s_waitcnt lgkmcnt(8)
    v_mfma_f32_16x16x32_bf16 v[216:219], v[32:35], v[112:115], v[216:219]
    ds_read_b128 v[72:75], v20 offset:6144
    v_cvt_pk_bf16_f32 v93, v171, v175
    v_mfma_f32_16x16x32_bf16 v[216:219], v[36:39], v[116:119], v[216:219]
    ds_read_b128 v[76:79], v21 offset:6144
    v_cvt_pk_bf16_f32 v94, v179, v183
    v_mfma_f32_16x16x32_bf16 v[248:251], v[40:43], v[112:115], v[248:251]
    ds_read_b128 v[104:107], v22 offset:512
    v_cvt_pk_bf16_f32 v95, v187, v191
    v_mfma_f32_16x16x32_bf16 v[248:251], v[44:47], v[116:119], v[248:251]
    ds_read_b128 v[108:111], v22 offset:8704
    s_waitcnt lgkmcnt(8)
    v_mfma_f32_16x16x32_bf16 v[252:255], v[40:43], v[120:123], v[252:255]
    ds_read_b128 v[112:115], v22 offset:1024
    s_add_u32 s34, s29, 136192
    v_mfma_f32_16x16x32_bf16 v[252:255], v[44:47], v[124:127], v[252:255]
    ds_read_b128 v[116:119], v22 offset:9216
    buffer_store_dwordx4 v[92:95], v24, s[36:39], s34 offen nt
    v_mfma_f32_16x16x32_bf16 v[220:223], v[32:35], v[120:123], v[220:223]
    v_mfma_f32_16x16x32_bf16 v[220:223], v[36:39], v[124:127], v[220:223]
    s_waitcnt lgkmcnt(6)
    v_mfma_f32_16x16x32_bf16 v[192:195], v[64:67], v[96:99], v[192:195]
    ds_read_b128 v[120:123], v22 offset:1536
    v_mfma_f32_16x16x32_bf16 v[192:195], v[68:71], v[100:103], v[192:195]
    ds_read_b128 v[124:127], v22 offset:9728
    s_waitcnt lgkmcnt(4)
    v_mfma_f32_16x16x32_bf16 v[196:199], v[64:67], v[104:107], v[196:199]
    v_mfma_f32_16x16x32_bf16 v[196:199], v[68:71], v[108:111], v[196:199]
    s_waitcnt lgkmcnt(2)
    v_mfma_f32_16x16x32_bf16 v[200:203], v[64:67], v[112:115], v[200:203]
    v_mfma_f32_16x16x32_bf16 v[200:203], v[68:71], v[116:119], v[200:203]
    v_mfma_f32_16x16x32_bf16 v[208:211], v[64:67], v[128:131], v[208:211]
    v_mfma_f32_16x16x32_bf16 v[208:211], v[68:71], v[132:135], v[208:211]
    v_mfma_f32_16x16x32_bf16 v[212:215], v[64:67], v[136:139], v[212:215]
    v_mfma_f32_16x16x32_bf16 v[212:215], v[68:71], v[140:143], v[212:215]
    v_mfma_f32_16x16x32_bf16 v[216:219], v[64:67], v[144:147], v[216:219]
    v_mfma_f32_16x16x32_bf16 v[216:219], v[68:71], v[148:151], v[216:219]
    v_mfma_f32_16x16x32_bf16 v[220:223], v[64:67], v[152:155], v[220:223]
    v_mfma_f32_16x16x32_bf16 v[220:223], v[68:71], v[156:159], v[220:223]
    s_waitcnt lgkmcnt(0)
    v_mfma_f32_16x16x32_bf16 v[204:207], v[64:67], v[120:123], v[204:207]
    v_mfma_f32_16x16x32_bf16 v[204:207], v[68:71], v[124:127], v[204:207]
    v_mfma_f32_16x16x32_bf16 v[224:227], v[72:75], v[96:99], v[224:227]
    s_nop 0
    v_mfma_f32_16x16x32_bf16 v[224:227], v[76:79], v[100:103], v[224:227]
    s_nop 0
    v_mfma_f32_16x16x32_bf16 v[228:231], v[72:75], v[104:107], v[228:231]
    s_nop 0
    v_mfma_f32_16x16x32_bf16 v[228:231], v[76:79], v[108:111], v[228:231]
    s_nop 0
    v_mfma_f32_16x16x32_bf16 v[232:235], v[72:75], v[112:115], v[232:235]
    v_cvt_pk_bf16_f32 v48, v192, v196
    v_cvt_pk_bf16_f32 v49, v200, v204
    v_mfma_f32_16x16x32_bf16 v[232:235], v[76:79], v[116:119], v[232:235]
    v_cvt_pk_bf16_f32 v50, v208, v212
    v_cvt_pk_bf16_f32 v51, v216, v220
    v_mfma_f32_16x16x32_bf16 v[240:243], v[72:75], v[128:131], v[240:243]
    s_add_u32 s34, s29, 229376
    buffer_store_dwordx4 v[48:51], v24, s[36:39], s34 offen nt
    v_mfma_f32_16x16x32_bf16 v[240:243], v[76:79], v[132:135], v[240:243]
    v_cvt_pk_bf16_f32 v52, v193, v197
    v_cvt_pk_bf16_f32 v53, v201, v205
    v_mfma_f32_16x16x32_bf16 v[244:247], v[72:75], v[136:139], v[244:247]
    v_cvt_pk_bf16_f32 v54, v209, v213
    v_cvt_pk_bf16_f32 v55, v217, v221
    v_mfma_f32_16x16x32_bf16 v[244:247], v[76:79], v[140:143], v[244:247]
    s_add_u32 s34, s29, 236544
    buffer_store_dwordx4 v[52:55], v24, s[36:39], s34 offen nt
    v_mfma_f32_16x16x32_bf16 v[248:251], v[72:75], v[144:147], v[248:251]
    v_cvt_pk_bf16_f32 v56, v194, v198
    v_cvt_pk_bf16_f32 v57, v202, v206
    v_mfma_f32_16x16x32_bf16 v[248:251], v[76:79], v[148:151], v[248:251]
    v_cvt_pk_bf16_f32 v58, v210, v214
    v_cvt_pk_bf16_f32 v59, v218, v222
    v_mfma_f32_16x16x32_bf16 v[252:255], v[72:75], v[152:155], v[252:255]
    s_add_u32 s34, s29, 243712
    buffer_store_dwordx4 v[56:59], v24, s[36:39], s34 offen nt
    v_mfma_f32_16x16x32_bf16 v[252:255], v[76:79], v[156:159], v[252:255]
    v_cvt_pk_bf16_f32 v60, v195, v199
    v_cvt_pk_bf16_f32 v61, v203, v207
    v_mfma_f32_16x16x32_bf16 v[236:239], v[72:75], v[120:123], v[236:239]
    v_cvt_pk_bf16_f32 v62, v211, v215
    v_cvt_pk_bf16_f32 v63, v219, v223
    v_mfma_f32_16x16x32_bf16 v[236:239], v[76:79], v[124:127], v[236:239]
    s_add_u32 s34, s29, 250880
    buffer_store_dwordx4 v[60:63], v24, s[36:39], s34 offen nt
    s_nop 7
    v_cvt_pk_bf16_f32 v32, v224, v228
    v_cvt_pk_bf16_f32 v33, v232, v236
    v_cvt_pk_bf16_f32 v34, v240, v244
    v_cvt_pk_bf16_f32 v35, v248, v252
    s_add_u32 s34, s29, 344064
    buffer_store_dwordx4 v[32:35], v24, s[36:39], s34 offen nt
    v_cvt_pk_bf16_f32 v36, v225, v229
    v_cvt_pk_bf16_f32 v37, v233, v237
    v_cvt_pk_bf16_f32 v38, v241, v245
    v_cvt_pk_bf16_f32 v39, v249, v253
    s_add_u32 s34, s29, 351232
    buffer_store_dwordx4 v[36:39], v24, s[36:39], s34 offen nt
    v_cvt_pk_bf16_f32 v40, v226, v230
    v_cvt_pk_bf16_f32 v41, v234, v238
    v_cvt_pk_bf16_f32 v42, v242, v246
    v_cvt_pk_bf16_f32 v43, v250, v254
    s_add_u32 s34, s29, 358400
    buffer_store_dwordx4 v[40:43], v24, s[36:39], s34 offen nt
    v_cvt_pk_bf16_f32 v44, v227, v231
    v_cvt_pk_bf16_f32 v45, v235, v239
    v_cvt_pk_bf16_f32 v46, v243, v247
    v_cvt_pk_bf16_f32 v47, v251, v255
    s_add_u32 s34, s29, 365568
    buffer_store_dwordx4 v[44:47], v24, s[36:39], s34 offen nt
L_end:
    s_endpgm
.p2align 6
L_prod:
    s_lshr_b32 s56, s22, 2
    s_xor_b32 s3, s2, s56
    s_sub_u32 s24, s2, 28
    s_mul_i32 s24, s24, 7
    s_add_u32 s24, s24, s56
    s_cmp_lt_u32 s22, 4
    s_cselect_b32 s56, 32, 36
    s_mov_b32 s26, 0xec
    s_cselect_b32 s26, 0xdba, s26
    s_mov_b32 s27, 0xff
    s_cselect_b32 s27, 0xfff, s27
    s_cmp_ge_u32 s2, 28
    s_cselect_b32 s21, s24, s3
    s_cselect_b32 s65, 0, 1
    s_cselect_b32 s56, 60, s56
    s_cselect_b32 s26, s27, s26
    s_cselect_b32 s57, 2, 0
    s_and_b32 s24, s22, 3
    s_add_u32 s56, s56, s24
    s_mul_i32 s53, s56, 229376
    s_lshl_b32 s25, s21, 9
    s_add_u32 s53, s53, s25
    s_lshr_b32 s54, s56, 1
    s_mul_i32 s54, s54, 7168
    s_lshl_b32 s25, s21, 8
    s_add_u32 s54, s54, s25
    s_lshl_b32 s30, s21, 7
    s_add_u32 s30, s30, 7598080
    s_mov_b32 s38, 14680064
    s_mov_b32 s39, 0x20000
    s_mov_b32 s42, 229376
    s_mov_b32 s43, 0x20000
    s_mov_b32 s46, 229376
    s_mov_b32 s47, 0x20000
    s_waitcnt lgkmcnt(0)
    s_mov_b32 s36, s6
    s_and_b32 s37, s7, 0xffff
    s_mov_b32 s40, s8
    s_and_b32 s41, s9, 0xffff
    s_mov_b32 s44, s10
    s_and_b32 s45, s11, 0xffff
    buffer_load_dwordx4 v[32:35], v4, s[36:39], s53 offen
    s_add_u32 s34, s53, 14336
    buffer_load_dwordx4 v[36:39], v4, s[36:39], s34 offen
    s_add_u32 s34, s53, 28672
    buffer_load_dwordx4 v[40:43], v4, s[36:39], s34 offen
    s_add_u32 s34, s53, 43008
    buffer_load_dwordx4 v[44:47], v4, s[36:39], s34 offen
    s_add_u32 s34, s53, 57344
    buffer_load_dwordx4 v[48:51], v4, s[36:39], s34 offen
    s_add_u32 s34, s53, 71680
    buffer_load_dwordx4 v[52:55], v4, s[36:39], s34 offen
    s_add_u32 s34, s53, 86016
    buffer_load_dwordx4 v[56:59], v4, s[36:39], s34 offen
    s_add_u32 s34, s53, 100352
    buffer_load_dwordx4 v[60:63], v4, s[36:39], s34 offen
    buffer_load_dwordx2 v[64:65], v5, s[40:43], s54 offen
    buffer_load_dwordx2 v[66:67], v5, s[44:47], s54 offen
    s_load_dword s23, s[16:17], s30
    s_mov_b32 s48, s16
    s_and_b32 s49, s17, 0xffff
    s_mov_b32 s50, 8388608
    s_mov_b32 s51, 0x20000
    v_xor_b32 v8, v7, v6
    v_lshlrev_b32 v8, 4, v8
    v_lshl_add_u32 v8, v6, 11, v8
    v_cmp_gt_u32 vcc, 32, v2
    v_lshlrev_b32 v3, 2, v2
    v_mov_b32 v9, 1073741824
    v_cndmask_b32 v25, v9, v3, vcc
    s_mul_i32 s35, s21, 262144
    s_lshl_b32 s25, s56, 12
    s_add_u32 s35, s35, s25
    s_mul_i32 s58, s21, 9216
    s_add_u32 s58, s58, 7340032
    s_lshl_b32 s25, s56, 7
    s_add_u32 s52, s58, s25
    s_waitcnt vmcnt(0)
L_ploop:
    v_lshlrev_b32 v68, 16, v64
    v_lshlrev_b32 v72, 16, v66
    v_and_b32 v69, 0xffff0000, v64
    v_and_b32 v73, 0xffff0000, v66
    v_lshlrev_b32 v70, 16, v65
    v_lshlrev_b32 v74, 16, v67
    v_and_b32 v71, 0xffff0000, v65
    v_and_b32 v75, 0xffff0000, v67
    v_mul_f32_e64 v72, -v72, v68
    v_mul_f32_e64 v73, -v73, v69
    v_mul_f32_e64 v74, -v74, v70
    v_mul_f32_e64 v75, -v75, v71
    v_cvt_f32_i32 v32, v32
    v_cvt_f32_i32 v36, v36
    v_cvt_f32_i32 v40, v40
    v_cvt_f32_i32 v44, v44
    v_cvt_f32_i32 v48, v48
    v_cvt_f32_i32 v52, v52
    v_cvt_f32_i32 v56, v56
    v_cvt_f32_i32 v60, v60
    v_fma_f32 v32, v32, v68, v72
    v_fma_f32 v36, v36, v68, v72
    v_fma_f32 v40, v40, v68, v72
    v_fma_f32 v44, v44, v68, v72
    v_fma_f32 v48, v48, v68, v72
    v_fma_f32 v52, v52, v68, v72
    v_fma_f32 v56, v56, v68, v72
    v_fma_f32 v60, v60, v68, v72
    v_cvt_pk_bf16_f32 v80, v32, v36
    v_cvt_pk_bf16_f32 v81, v40, v44
    v_cvt_pk_bf16_f32 v82, v48, v52
    v_cvt_pk_bf16_f32 v83, v56, v60
    buffer_store_dwordx4 v[80:83], v8, s[48:51], s35 offen offset:0 sc1
    v_cvt_f32_i32 v33, v33
    v_cvt_f32_i32 v37, v37
    v_cvt_f32_i32 v41, v41
    v_cvt_f32_i32 v45, v45
    v_cvt_f32_i32 v49, v49
    v_cvt_f32_i32 v53, v53
    v_cvt_f32_i32 v57, v57
    v_cvt_f32_i32 v61, v61
    v_fma_f32 v33, v33, v69, v73
    v_fma_f32 v37, v37, v69, v73
    v_fma_f32 v41, v41, v69, v73
    v_fma_f32 v45, v45, v69, v73
    v_fma_f32 v49, v49, v69, v73
    v_fma_f32 v53, v53, v69, v73
    v_fma_f32 v57, v57, v69, v73
    v_fma_f32 v61, v61, v69, v73
    v_cvt_pk_bf16_f32 v84, v33, v37
    v_cvt_pk_bf16_f32 v85, v41, v45
    v_cvt_pk_bf16_f32 v86, v49, v53
    v_cvt_pk_bf16_f32 v87, v57, v61
    buffer_store_dwordx4 v[84:87], v8, s[48:51], s35 offen offset:512 sc1
    v_cvt_f32_i32 v34, v34
    v_cvt_f32_i32 v38, v38
    v_cvt_f32_i32 v42, v42
    v_cvt_f32_i32 v46, v46
    v_cvt_f32_i32 v50, v50
    v_cvt_f32_i32 v54, v54
    v_cvt_f32_i32 v58, v58
    v_cvt_f32_i32 v62, v62
    v_fma_f32 v34, v34, v70, v74
    v_fma_f32 v38, v38, v70, v74
    v_fma_f32 v42, v42, v70, v74
    v_fma_f32 v46, v46, v70, v74
    v_fma_f32 v50, v50, v70, v74
    v_fma_f32 v54, v54, v70, v74
    v_fma_f32 v58, v58, v70, v74
    v_fma_f32 v62, v62, v70, v74
    v_cvt_pk_bf16_f32 v88, v34, v38
    v_cvt_pk_bf16_f32 v89, v42, v46
    v_cvt_pk_bf16_f32 v90, v50, v54
    v_cvt_pk_bf16_f32 v91, v58, v62
    buffer_store_dwordx4 v[88:91], v8, s[48:51], s35 offen offset:1024 sc1
    v_cvt_f32_i32 v35, v35
    v_cvt_f32_i32 v39, v39
    v_cvt_f32_i32 v43, v43
    v_cvt_f32_i32 v47, v47
    v_cvt_f32_i32 v51, v51
    v_cvt_f32_i32 v55, v55
    v_cvt_f32_i32 v59, v59
    v_cvt_f32_i32 v63, v63
    v_fma_f32 v35, v35, v71, v75
    v_fma_f32 v39, v39, v71, v75
    v_fma_f32 v43, v43, v71, v75
    v_fma_f32 v47, v47, v71, v75
    v_fma_f32 v51, v51, v71, v75
    v_fma_f32 v55, v55, v71, v75
    v_fma_f32 v59, v59, v71, v75
    v_fma_f32 v63, v63, v71, v75
    v_cvt_pk_bf16_f32 v92, v35, v39
    v_cvt_pk_bf16_f32 v93, v43, v47
    v_cvt_pk_bf16_f32 v94, v51, v55
    v_cvt_pk_bf16_f32 v95, v59, v63
    buffer_store_dwordx4 v[92:95], v8, s[48:51], s35 offen offset:1536 sc1
    s_waitcnt lgkmcnt(0)
    s_add_u32 s59, s23, 2654435761
    s_or_b32 s59, s59, 1
    v_mov_b32 v26, s59
    s_cmp_eq_u32 s26, 0
    s_cbranch_scc1 L_plast
    s_and_b32 s24, s26, 15
    s_lshr_b32 s26, s26, 4
    s_lshl_b32 s24, s24, 2
    s_and_b32 s56, s56, 3
    s_add_u32 s56, s56, s24
    s_add_u32 s21, s21, s57
    s_xor_b32 s21, s21, s65
    s_mul_i32 s53, s56, 229376
    s_lshl_b32 s25, s21, 9
    s_add_u32 s53, s53, s25
    s_lshr_b32 s54, s56, 1
    s_mul_i32 s54, s54, 7168
    s_lshl_b32 s25, s21, 8
    s_add_u32 s54, s54, s25
    s_lshl_b32 s30, s21, 7
    s_add_u32 s30, s30, 7598080
    buffer_load_dwordx4 v[32:35], v4, s[36:39], s53 offen
    s_add_u32 s34, s53, 14336
    buffer_load_dwordx4 v[36:39], v4, s[36:39], s34 offen
    s_add_u32 s34, s53, 28672
    buffer_load_dwordx4 v[40:43], v4, s[36:39], s34 offen
    s_add_u32 s34, s53, 43008
    buffer_load_dwordx4 v[44:47], v4, s[36:39], s34 offen
    s_add_u32 s34, s53, 57344
    buffer_load_dwordx4 v[48:51], v4, s[36:39], s34 offen
    s_add_u32 s34, s53, 71680
    buffer_load_dwordx4 v[52:55], v4, s[36:39], s34 offen
    s_add_u32 s34, s53, 86016
    buffer_load_dwordx4 v[56:59], v4, s[36:39], s34 offen
    s_add_u32 s34, s53, 100352
    buffer_load_dwordx4 v[60:63], v4, s[36:39], s34 offen
    buffer_load_dwordx2 v[64:65], v5, s[40:43], s54 offen
    buffer_load_dwordx2 v[66:67], v5, s[44:47], s54 offen
    s_load_dword s23, s[16:17], s30
    s_waitcnt vmcnt(10)
    buffer_store_dword v26, v25, s[48:51], s52 offen sc1
    s_mul_i32 s35, s21, 262144
    s_lshl_b32 s25, s56, 12
    s_add_u32 s35, s35, s25
    s_mul_i32 s58, s21, 9216
    s_add_u32 s58, s58, 7340032
    s_lshl_b32 s25, s56, 7
    s_add_u32 s52, s58, s25
    s_waitcnt vmcnt(1)
    s_branch L_ploop
L_plast:
    s_waitcnt vmcnt(0)
    buffer_store_dword v26, v25, s[48:51], s52 offen sc1
    s_barrier
    s_cmp_ge_u32 s2, 28
    s_cselect_b32 s24, 1, s22
    s_cmp_lg_u32 s24, 0
    s_cbranch_scc1 L_end
    v_min_u32 v11, 39, v2
    v_add_u32 v11, 32, v11
    v_lshlrev_b32 v11, 7, v11
    s_mov_b32 s31, 262144
L_pe:
    buffer_load_dword v12, v11, s[48:51], s58 offen sc1
    s_sub_u32 s31, s31, 1
    s_waitcnt vmcnt(0)
    v_cmp_ne_u32 vcc, s59, v12
    s_cbranch_vccz L_pe_ok
    s_sleep 8
    s_cmp_lg_u32 s31, 0
    s_cbranch_scc1 L_pe
L_pe_ok:
    buffer_store_dword v26, v25, s[48:51], s30 offen sc1
    s_endpgm
.p2align 6
L_help:
    s_and_b32 s55, s22, 1
    s_lshl_b32 s64, s20, 7
    s_lshl_b32 s24, s21, 1
    s_add_u32 s24, s24, s55
    s_mul_i32 s24, s24, 1170
    s_lshr_b32 s24, s24, 8
    s_min_u32 s24, s24, 251
    s_lshl_b32 s25, s20, 8
    s_add_u32 s24, s24, s25
    s_lshl_b32 s33, s24, 11
    s_cmp_ge_u32 s22, 6
    s_cbranch_scc1 L_loadb
    v_lshrrev_b32 v10, 3, v2
    v_and_b32 v11, 6, v10
    v_and_b32 v12, 7, v2
    v_xor_b32 v11, v11, v12
    v_lshlrev_b32 v11, 4, v11
    s_lshl_b32 s24, s20, 1
    s_add_u32 s24, s24, s55
    s_lshl_b32 s24, s24, 7
    v_add_u32 v13, s24, v10
    v_lshl_add_u32 v16, v13, 11, v11
    v_add_u32 v17, 15360, v16
    v_add_u32 v18, 30720, v16
    v_add_u32 v19, 46080, v16
    s_lshl_b32 s57, s55, 14
    s_waitcnt lgkmcnt(0)
    s_mov_b32 s60, s4
    s_and_b32 s61, s5, 0xffff
    s_mov_b32 s62, 4194304
    s_mov_b32 s63, 0x20000
    s_add_u32 s4, s4, s33
    s_addc_u32 s5, s5, 0
    s_xor_b32 s24, s64, 128
    s_add_u32 s14, s4, s24
    s_addc_u32 s15, s5, 0
    s_waitcnt lgkmcnt(0)
    s_load_dwordx2 s[10:11], s[14:15], 60
    s_load_dwordx2 s[10:11], s[14:15], 2108
    s_load_dwordx2 s[10:11], s[14:15], 4156
    s_load_dwordx2 s[10:11], s[14:15], 6204
    s_load_dwordx2 s[10:11], s[14:15], 8252
    s_xor_b32 s32, s64, 0
    s_add_u32 m0, s57, 0
    s_add_u32 s34, s32, 0
    buffer_load_dwordx4 v16, s[60:63], s34 offen offset:0  lds
    buffer_load_dwordx4 v17, s[60:63], s34 offen offset:1024  lds
    buffer_load_dwordx4 v18, s[60:63], s34 offen offset:2048  lds
    buffer_load_dwordx4 v19, s[60:63], s34 offen offset:3072  lds
    s_add_u32 m0, s57, 4096
    s_add_u32 s34, s32, 65536
    buffer_load_dwordx4 v16, s[60:63], s34 offen offset:0  lds
    buffer_load_dwordx4 v17, s[60:63], s34 offen offset:1024  lds
    buffer_load_dwordx4 v18, s[60:63], s34 offen offset:2048  lds
    buffer_load_dwordx4 v19, s[60:63], s34 offen offset:3072  lds
    s_add_u32 m0, s57, 8192
    s_add_u32 s34, s32, 131072
    buffer_load_dwordx4 v16, s[60:63], s34 offen offset:0  lds
    buffer_load_dwordx4 v17, s[60:63], s34 offen offset:1024  lds
    buffer_load_dwordx4 v18, s[60:63], s34 offen offset:2048  lds
    buffer_load_dwordx4 v19, s[60:63], s34 offen offset:3072  lds
    s_add_u32 m0, s57, 12288
    s_add_u32 s34, s32, 196608
    buffer_load_dwordx4 v16, s[60:63], s34 offen offset:0  lds
    buffer_load_dwordx4 v17, s[60:63], s34 offen offset:1024  lds
    buffer_load_dwordx4 v18, s[60:63], s34 offen offset:2048  lds
    buffer_load_dwordx4 v19, s[60:63], s34 offen offset:3072  lds
    s_xor_b32 s24, s64, 384
    s_add_u32 s14, s4, s24
    s_addc_u32 s15, s5, 0
    s_waitcnt lgkmcnt(0)
    s_load_dwordx2 s[10:11], s[14:15], 60
    s_load_dwordx2 s[10:11], s[14:15], 2108
    s_load_dwordx2 s[10:11], s[14:15], 4156
    s_load_dwordx2 s[10:11], s[14:15], 6204
    s_load_dwordx2 s[10:11], s[14:15], 8252
    s_waitcnt vmcnt(0)
    s_barrier
    s_xor_b32 s24, s64, 640
    s_add_u32 s14, s4, s24
    s_addc_u32 s15, s5, 0
    s_waitcnt lgkmcnt(0)
    s_load_dwordx2 s[10:11], s[14:15], 60
    s_load_dwordx2 s[10:11], s[14:15], 2108
    s_load_dwordx2 s[10:11], s[14:15], 4156
    s_load_dwordx2 s[10:11], s[14:15], 6204
    s_load_dwordx2 s[10:11], s[14:15], 8252
    s_xor_b32 s32, s64, 128
    s_add_u32 m0, s57, 49152
    s_add_u32 s34, s32, 0
    buffer_load_dwordx4 v16, s[60:63], s34 offen offset:0  lds
    buffer_load_dwordx4 v17, s[60:63], s34 offen offset:1024  lds
    buffer_load_dwordx4 v18, s[60:63], s34 offen offset:2048  lds
    buffer_load_dwordx4 v19, s[60:63], s34 offen offset:3072  lds
    s_add_u32 m0, s57, 53248
    s_add_u32 s34, s32, 65536
    buffer_load_dwordx4 v16, s[60:63], s34 offen offset:0  lds
    buffer_load_dwordx4 v17, s[60:63], s34 offen offset:1024  lds
    buffer_load_dwordx4 v18, s[60:63], s34 offen offset:2048  lds
    buffer_load_dwordx4 v19, s[60:63], s34 offen offset:3072  lds
    s_add_u32 m0, s57, 57344
    s_add_u32 s34, s32, 131072
    buffer_load_dwordx4 v16, s[60:63], s34 offen offset:0  lds
    buffer_load_dwordx4 v17, s[60:63], s34 offen offset:1024  lds
    buffer_load_dwordx4 v18, s[60:63], s34 offen offset:2048  lds
    buffer_load_dwordx4 v19, s[60:63], s34 offen offset:3072  lds
    s_add_u32 m0, s57, 61440
    s_add_u32 s34, s32, 196608
    buffer_load_dwordx4 v16, s[60:63], s34 offen offset:0  lds
    buffer_load_dwordx4 v17, s[60:63], s34 offen offset:1024  lds
    buffer_load_dwordx4 v18, s[60:63], s34 offen offset:2048  lds
    buffer_load_dwordx4 v19, s[60:63], s34 offen offset:3072  lds
    s_xor_b32 s32, s64, 256
    s_add_u32 m0, s57, 98304
    s_add_u32 s34, s32, 0
    buffer_load_dwordx4 v16, s[60:63], s34 offen offset:0  lds
    buffer_load_dwordx4 v17, s[60:63], s34 offen offset:1024  lds
    buffer_load_dwordx4 v18, s[60:63], s34 offen offset:2048  lds
    buffer_load_dwordx4 v19, s[60:63], s34 offen offset:3072  lds
    s_add_u32 m0, s57, 102400
    s_add_u32 s34, s32, 65536
    buffer_load_dwordx4 v16, s[60:63], s34 offen offset:0  lds
    buffer_load_dwordx4 v17, s[60:63], s34 offen offset:1024  lds
    buffer_load_dwordx4 v18, s[60:63], s34 offen offset:2048  lds
    buffer_load_dwordx4 v19, s[60:63], s34 offen offset:3072  lds
    s_add_u32 m0, s57, 106496
    s_add_u32 s34, s32, 131072
    buffer_load_dwordx4 v16, s[60:63], s34 offen offset:0  lds
    buffer_load_dwordx4 v17, s[60:63], s34 offen offset:1024  lds
    buffer_load_dwordx4 v18, s[60:63], s34 offen offset:2048  lds
    buffer_load_dwordx4 v19, s[60:63], s34 offen offset:3072  lds
    s_add_u32 m0, s57, 110592
    s_add_u32 s34, s32, 196608
    buffer_load_dwordx4 v16, s[60:63], s34 offen offset:0  lds
    buffer_load_dwordx4 v17, s[60:63], s34 offen offset:1024  lds
    buffer_load_dwordx4 v18, s[60:63], s34 offen offset:2048  lds
    buffer_load_dwordx4 v19, s[60:63], s34 offen offset:3072  lds
    s_waitcnt vmcnt(16)
    s_barrier
    s_movk_i32 s36, 384
    s_add_u32 s37, s57, 0
    s_add_u32 s38, s57, 147456
L_aloop:
    s_xor_b32 s32, s36, s64
    s_cmp_lt_u32 s36, 1024
    s_cselect_b32 s32, s32, s36
    s_add_u32 m0, s37, 0
    s_add_u32 s34, s32, 0
    buffer_load_dwordx4 v16, s[60:63], s34 offen offset:0  lds
    buffer_load_dwordx4 v17, s[60:63], s34 offen offset:1024  lds
    buffer_load_dwordx4 v18, s[60:63], s34 offen offset:2048  lds
    buffer_load_dwordx4 v19, s[60:63], s34 offen offset:3072  lds
    s_add_u32 m0, s37, 8192
    s_add_u32 s34, s32, 131072
    buffer_load_dwordx4 v16, s[60:63], s34 offen offset:0  lds
    buffer_load_dwordx4 v17, s[60:63], s34 offen offset:1024  lds
    buffer_load_dwordx4 v18, s[60:63], s34 offen offset:2048  lds
    buffer_load_dwordx4 v19, s[60:63], s34 offen offset:3072  lds
    s_add_u32 m0, s37, 4096
    s_add_u32 s34, s32, 65536
    buffer_load_dwordx4 v16, s[60:63], s34 offen offset:0  lds
    buffer_load_dwordx4 v17, s[60:63], s34 offen offset:1024  lds
    buffer_load_dwordx4 v18, s[60:63], s34 offen offset:2048  lds
    buffer_load_dwordx4 v19, s[60:63], s34 offen offset:3072  lds
    s_add_u32 m0, s37, 12288
    s_add_u32 s34, s32, 196608
    buffer_load_dwordx4 v16, s[60:63], s34 offen offset:0  lds
    buffer_load_dwordx4 v17, s[60:63], s34 offen offset:1024  lds
    buffer_load_dwordx4 v18, s[60:63], s34 offen offset:2048  lds
    buffer_load_dwordx4 v19, s[60:63], s34 offen offset:3072  lds
    s_add_u32 s25, s36, 384
    s_cmp_ge_u32 s25, 2048
    s_cbranch_scc1 L_anox
    s_xor_b32 s24, s25, s64
    s_cmp_lt_u32 s25, 1024
    s_cselect_b32 s24, s24, s25
    s_add_u32 s14, s4, s24
    s_addc_u32 s15, s5, 0
    s_waitcnt lgkmcnt(0)
    s_load_dwordx2 s[10:11], s[14:15], 60
    s_load_dwordx2 s[10:11], s[14:15], 2108
    s_load_dwordx2 s[10:11], s[14:15], 4156
    s_load_dwordx2 s[10:11], s[14:15], 6204
    s_load_dwordx2 s[10:11], s[14:15], 8252
L_anox:
    s_add_u32 s37, s37, 49152
    s_cmp_eq_u32 s37, s38
    s_cselect_b32 s37, s57, s37
    s_add_u32 s36, s36, 128
    s_cmp_lt_u32 s36, 2048
    s_waitcnt vmcnt(16)
    s_barrier
    s_cbranch_scc1 L_aloop
    s_waitcnt vmcnt(8)
    s_barrier
    s_waitcnt vmcnt(0)
    s_barrier
    s_endpgm
.p2align 6
L_loadb:
    s_mov_b64 exec, 0
    s_branch L_stub
L_stubr:
    s_mov_b64 exec, -1
    v_lshlrev_b32 v3, 4, v2
    s_lshl_b32 s30, s21, 7
    s_add_u32 s30, s30, 7598080
    s_lshl_b32 s58, s55, 13
    s_mul_i32 s59, s21, 262144
    s_add_u32 s59, s59, s58
    s_add_u32 s58, s58, 32768
    s_mul_i32 s28, s21, 9216
    s_add_u32 s28, s28, 7340032
    s_lshl_b32 s25, s55, 8
    s_add_u32 s29, s28, s25
    s_add_u32 s28, s28, s64
    s_add_u32 s28, s28, 8192
    v_cmp_eq_u32 vcc, 384, v0
    v_mov_b32 v14, 1073741824
    s_waitcnt lgkmcnt(0)
    v_cndmask_b32 v14, v14, v2, vcc
    s_mov_b32 s48, s16
    s_and_b32 s49, s17, 0xffff
    s_mov_b32 s50, 8388608
    s_mov_b32 s51, 0x20000
    s_add_u32 s26, s16, s29
    s_addc_u32 s27, s17, 0
    s_add_u32 s6, s26, 128
    s_addc_u32 s7, s27, 0
    s_load_dword s8, s[16:17], s30
    s_add_u32 s4, s4, s33
    s_addc_u32 s5, s5, 0
    s_mov_b32 s33, 1
    s_xor_b32 s24, s64, 256
    s_add_u32 s14, s4, s24
    s_addc_u32 s15, s5, 0
    s_load_dwordx2 s[10:11], s[14:15], 60
    s_load_dwordx2 s[10:11], s[14:15], 2108
    s_load_dwordx2 s[10:11], s[14:15], 4156
    s_load_dwordx2 s[10:11], s[14:15], 6204
    s_load_dwordx2 s[10:11], s[14:15], 8252
    s_waitcnt lgkmcnt(0)
    s_add_u32 s8, s8, 2654435761
    s_or_b32 s8, s8, 1
    s_mov_b32 s9, s8
    v_mov_b32 v15, s8
    s_xor_b32 s24, s64, 512
    s_add_u32 s14, s4, s24
    s_addc_u32 s15, s5, 0
    s_waitcnt lgkmcnt(0)
    s_load_dwordx2 s[10:11], s[14:15], 60
    s_load_dwordx2 s[10:11], s[14:15], 2108
    s_load_dwordx2 s[10:11], s[14:15], 4156
    s_load_dwordx2 s[10:11], s[14:15], 6204
    s_load_dwordx2 s[10:11], s[14:15], 8252
    s_barrier
    buffer_store_dword v15, v14, s[48:51], s28 offen sc1
    s_movk_i32 s38, 256
    s_movk_i32 s39, 128
    s_add_u32 s40, s58, 98304
    s_add_u32 s41, s58, 147456
    s_mov_b64 s[36:37], 0
    v_mov_b32 v20, 0
    v_lshlrev_b32 v21, 7, v2
    s_mov_b32 s42, 2
    s_mov_b32 s31, 262144
    s_mov_b64 s[46:47], 0
    s_xor_b32 s32, s38, s64
    s_cmp_lt_u32 s38, 1024
    s_cselect_b32 s32, s32, s38
    s_lshl_b32 s24, s32, 2
    s_load_dword s36, s[26:27], s24 glc
    s_load_dword s37, s[6:7], s24 glc
L_bloop:
    s_add_u32 s43, s39, 128
    s_min_u32 s43, s43, 1920
    s_cmp_eq_u32 s43, 1920
    s_cselect_b32 s44, s43, s39
L_btop:
    s_cmp_gt_u32 s38, s43
    s_cbranch_scc1 L_bdone
    s_cmp_gt_u32 s38, s44
    s_subb_u32 s42, s42, 0
    s_cbranch_scc1 L_bdone
    s_waitcnt lgkmcnt(0)
    s_cmp_eq_u64 s[36:37], s[8:9]
    s_cbranch_scc1 L_bgo
    s_load_dword s36, s[26:27], s24 glc
    s_load_dword s37, s[6:7], s24 glc
    s_sub_u32 s31, s31, 1
    s_cbranch_scc0 L_btop
    s_mov_b32 s31, 0
    s_waitcnt vmcnt(0) lgkmcnt(0)
L_bgo:
    s_lshl_b32 s35, s32, 7
    s_add_u32 s35, s35, s59
    s_add_u32 s38, s38, 128
    s_xor_b32 s32, s38, s64
    s_cmp_lt_u32 s38, 1024
    s_cselect_b32 s32, s32, s38
    s_lshl_b32 s24, s32, 2
    s_load_dword s36, s[26:27], s24 glc
    s_load_dword s37, s[6:7], s24 glc
    s_add_u32 m0, s40, 0
    s_add_u32 s34, s35, 0
    buffer_load_dwordx4 v3, s[48:51], s34 offen offset:0 sc1 lds
    buffer_load_dwordx4 v3, s[48:51], s34 offen offset:1024 sc1 lds
    buffer_load_dwordx4 v3, s[48:51], s34 offen offset:2048 sc1 lds
    buffer_load_dwordx4 v3, s[48:51], s34 offen offset:3072 sc1 lds
    s_add_u32 m0, s40, 4096
    s_add_u32 s34, s35, 4096
    buffer_load_dwordx4 v3, s[48:51], s34 offen offset:0 sc1 lds
    buffer_load_dwordx4 v3, s[48:51], s34 offen offset:1024 sc1 lds
    buffer_load_dwordx4 v3, s[48:51], s34 offen offset:2048 sc1 lds
    buffer_load_dwordx4 v3, s[48:51], s34 offen offset:3072 sc1 lds
    s_add_u32 s40, s40, 49152
    s_cmp_eq_u32 s40, s41
    s_cselect_b32 s40, s58, s40
    s_branch L_btop
L_bdone:
    s_add_u32 s39, s39, 128
    s_cmp_gt_u32 s38, s39
    s_cbranch_scc1 L_bw
    s_waitcnt vmcnt(0)
L_bw:
    s_mov_b32 s42, 1
    s_waitcnt vmcnt(8)
    s_cmp_lt_u32 s39, 2048
    s_barrier
    s_cbranch_scc1 L_bloop
    s_endpgm
    s_endpgm
L_codeend:
    s_endpgm
    s_endpgm
    s_endpgm
    s_endpgm
    s_endpgm
    s_endpgm
    s_endpgm
    s_endpgm
    s_endpgm
    s_endpgm
    s_endpgm
    s_endpgm
    s_endpgm
    s_endpgm
    s_endpgm
    s_endpgm
    s_endpgm
    s_endpgm
    s_endpgm
    s_endpgm
    s_endpgm
    s_endpgm
    s_endpgm
    s_endpgm
    s_endpgm
    s_endpgm
    s_endpgm
    s_endpgm
    s_endpgm
    s_endpgm
    s_endpgm
    s_endpgm
.section .rodata,"a"
.p2align 6
.amdhsa_kernel standalone__w4a16_gemm_dequant__prompt_kernel
  .amdhsa_next_free_vgpr 256
  .amdhsa_next_free_sgpr 102
  .amdhsa_accum_offset 256
  .amdhsa_group_segment_fixed_size 0
  .amdhsa_kernarg_size 56
  .amdhsa_user_sgpr_count 2
  .amdhsa_user_sgpr_kernarg_segment_ptr 1
  .amdhsa_system_sgpr_workgroup_id_x 1
  .amdhsa_float_denorm_mode_32 3
.end_amdhsa_kernel
```
